```python
import torch

def _softmax(x, axis=-1):
    return torch.softmax(x, dim=axis)
def _gelu(x):
    return torch.nn.functional.gelu(x, approximate="tanh")
def _silu(x):
    return torch.nn.functional.silu(x)
def _sigmoid(x):
    return torch.sigmoid(x)
def _layernorm(x, axis=-1, eps=1e-5):
    m = x.mean(dim=axis, keepdim=True)
    v = x.var(dim=axis, keepdim=True, unbiased=False)
    return (x - m) / torch.sqrt(v + eps)
def _scatter_add(tgt, idx, src, axis=0):
    return tgt.clone().index_add_(axis, idx, src)
def _segment_sum(src, seg, n):
    out = torch.zeros((n,) + src.shape[1:], dtype=src.dtype)
    return out.index_add_(0, seg, src)
def _pad(x, pw):
    flat = tuple(v for pair in reversed(pw) for v in pair)
    return torch.nn.functional.pad(x, flat)

kernel_name = 'parallel_sum__mha_block_cached__glu_gated_swiglu__decode'

def setup_inputs():

    _w = (lambda a: (lambda t: t.to(torch.bfloat16) if t.is_floating_point() else t)(torch.as_tensor(a)))
    def _A_setup():
        B, Sq, D = 2, 1, 512
        H, Sk, Dh = 32, 16384, 128
        return {
            "x": _w((lambda *s: torch.randn(*s, dtype=torch.bfloat16) * 0.05)(B, Sq, D)),
            "k_cache": _w((lambda *s: torch.randn(*s, dtype=torch.bfloat16) * 1.6)(B, H, Sk, Dh)),
            "v_cache": _w((lambda *s: torch.randn(*s, dtype=torch.bfloat16) * 0.8)(B, H, Sk, Dh)),
            "wq": _w((lambda *s: torch.randn(*s, dtype=torch.bfloat16) * 1.6)(D, H * Dh) * (D ** -0.5)),
            "wo": _w((lambda *s: torch.randn(*s, dtype=torch.bfloat16) * 0.8)(H * Dh, D) * ((H * Dh) ** -0.5)),
        }
    _A_in = _A_setup()

    def _B_setup():
        B, S, D, F = 2, 1, 512, 1792
        return {
            "x": _w((lambda *s: torch.randn(*s, dtype=torch.bfloat16) * 0.05)(B, S, D)),
            "w1": _w((lambda *s: torch.randn(*s, dtype=torch.bfloat16) * 0.4)(D, F) * (2.0 / D) ** 0.5),
            "w3": _w((lambda *s: torch.randn(*s, dtype=torch.bfloat16) * 0.4)(D, F) * (2.0 / D) ** 0.5),
            "w2": _w((lambda *s: torch.randn(*s, dtype=torch.bfloat16) * 0.4)(F, D) * (2.0 / F) ** 0.5),
        }
    _B_in = _B_setup()

    return {
        "A_x": _A_in["x"],
        "A_k_cache": _A_in["k_cache"],
        "A_v_cache": _A_in["v_cache"],
        "A_wq": _A_in["wq"],
        "A_wo": _A_in["wo"],
        "B_x": _B_in["x"],
        "B_w1": _B_in["w1"],
        "B_w3": _B_in["w3"],
        "B_w2": _B_in["w2"],
    }

def reference(A_x, A_k_cache, A_v_cache, A_wq, A_wo, B_x, B_w1, B_w3, B_w2):
    def _A_ref(x, k_cache, v_cache, wq, wo):
        B, Sq, D = x.shape
        H, Dh = 32, 128
        q = (lambda x, *d: x.permute(*d))((x @ wq).reshape(B, Sq, H, Dh), 0, 2, 1, 3)
        scores = torch.einsum("bhqd,bhkd->bhqk", q, k_cache) * (Dh ** -0.5)
        p = _softmax(scores, axis=-1)
        o = torch.einsum("bhqk,bhkd->bhqd", p, v_cache)
        return (lambda x, *d: x.permute(*d))(o, 0, 2, 1, 3).reshape(B, Sq, H * Dh) @ wo

    def _B_ref(x, w1, w3, w2):
        gate = torch.einsum("bsd,df->bsf", x, w1)
        up = torch.einsum("bsd,df->bsf", x, w3)
        h = _silu(gate) * up
        out = torch.einsum("bsf,fd->bsd", h, w2)
        return out

    x = A_x
    xn = _layernorm(x, axis=-1)
    return x + _A_ref(xn, A_k_cache, A_v_cache, A_wq, A_wo) + _B_ref(xn, B_w1, B_w3, B_w2)
```

```asm
; @launch grid=(256,1,1) block=(512,1,1) lds=21632
.amdgcn_target "amdgcn-amd-amdhsa--gfx950"
.text
.globl parallel_sum__mha_block_cached__glu_gated_swiglu__decode_kernel
.p2align 8
.type parallel_sum__mha_block_cached__glu_gated_swiglu__decode_kernel,@function
parallel_sum__mha_block_cached__glu_gated_swiglu__decode_kernel:
  s_cmp_ge_u32 s2, 256
  s_cbranch_scc1 L_done
  s_load_dwordx16 s[4:19], s[0:1], 0
  s_load_dwordx8 s[20:27], s[0:1], 64
  v_lshrrev_b32 v2, 6, v0
  v_and_b32 v3, 63, v0
  v_readfirstlane_b32 s36, v2
  s_lshr_b32 s37, s2, 3
  s_and_b32 s38, s2, 7
  s_lshl_b32 s52, s38, 2
  s_and_b32 s40, s37, 3
  s_add_u32 s52, s52, s40
  s_lshr_b32 s53, s37, 2
  s_mov_b32 s50, 0x3fb8aa3b
  s_mov_b32 s51, 0x3db504f3
  s_mov_b32 s64, 0xffff0000
  s_mov_b32 s39, 0
  v_and_b32 v4, 15, v3
  v_lshrrev_b32 v5, 4, v3
  v_lshlrev_b32 v6, 4, v3
  s_cmp_ge_u32 s36, 4
  s_cbranch_scc1 L_helper
  s_and_b32 s63, s36, 1
  s_lshr_b32 s40, s36, 1
  s_lshl_b32 s41, s53, 1
  s_add_u32 s45, s40, s41
  s_lshl_b32 s41, s38, 1
  s_add_u32 s40, s40, s41
  s_add_u32 s67, s40, 288
  s_lshl_b32 s41, s63, 5
  s_add_u32 s42, s41, s52
  s_lshl_b32 s44, s42, 22
  s_add_u32 s42, s41, s37
  s_lshl_b32 s55, s42, 22
  s_lshl_b32 s42, s42, 8
  s_add_u32 s42, s42, 0x10000
  v_mov_b32 v115, s42
  s_mul_i32 s65, s67, 8192
  s_add_u32 s65, s65, s55
  s_mul_i32 s46, s45, 8192
  s_add_u32 s46, s46, s44
  s_add_u32 s47, s46, 4096
  s_waitcnt lgkmcnt(0)
  s_cmp_lg_u32 s36, 0
  s_cbranch_scc1 L_noln
  global_load_dwordx4 v[40:43], v6, s[4:5]
  global_load_dwordx4 v[44:47], v6, s[4:5] offset:1024
L_noln:
  s_mov_b32 s28, s6
  s_mov_b32 s29, s7
  s_mov_b32 s30, 0x10000000
  s_mov_b32 s31, 0x00020000
  s_mov_b32 s32, s8
  s_mov_b32 s33, s9
  s_mov_b32 s34, 0x10000000
  s_mov_b32 s35, 0x00020000
  s_cmp_lg_u32 s36, 0
  s_cbranch_scc1 L_ln_done
  s_waitcnt vmcnt(0)
  v_lshlrev_b32 v48, 16, v40
  v_and_b32 v49, s64, v40
  v_lshlrev_b32 v50, 16, v41
  v_and_b32 v51, s64, v41
  v_lshlrev_b32 v52, 16, v42
  v_and_b32 v53, s64, v42
  v_lshlrev_b32 v54, 16, v43
  v_and_b32 v55, s64, v43
  v_lshlrev_b32 v56, 16, v44
  v_and_b32 v57, s64, v44
  v_lshlrev_b32 v58, 16, v45
  v_and_b32 v59, s64, v45
  v_lshlrev_b32 v60, 16, v46
  v_and_b32 v61, s64, v46
  v_lshlrev_b32 v62, 16, v47
  v_and_b32 v63, s64, v47
  v_add_f32 v86, v48, v49
  v_add_f32 v86, v86, v50
  v_add_f32 v86, v86, v51
  v_add_f32 v86, v86, v52
  v_add_f32 v86, v86, v53
  v_add_f32 v86, v86, v54
  v_add_f32 v86, v86, v55
  v_add_f32 v87, v56, v57
  v_add_f32 v87, v87, v58
  v_add_f32 v87, v87, v59
  v_add_f32 v87, v87, v60
  v_add_f32 v87, v87, v61
  v_add_f32 v87, v87, v62
  v_add_f32 v87, v87, v63
  s_nop 1
  v_add_f32_dpp v86, v86, v86 quad_perm:[1,0,3,2] row_mask:0xf bank_mask:0xf
  v_add_f32_dpp v87, v87, v87 quad_perm:[1,0,3,2] row_mask:0xf bank_mask:0xf
  s_nop 1
  v_add_f32_dpp v86, v86, v86 quad_perm:[2,3,0,1] row_mask:0xf bank_mask:0xf
  v_add_f32_dpp v87, v87, v87 quad_perm:[2,3,0,1] row_mask:0xf bank_mask:0xf
  s_nop 1
  v_add_f32_dpp v86, v86, v86 row_half_mirror row_mask:0xf bank_mask:0xf
  v_add_f32_dpp v87, v87, v87 row_half_mirror row_mask:0xf bank_mask:0xf
  s_nop 1
  v_add_f32_dpp v86, v86, v86 row_mirror row_mask:0xf bank_mask:0xf
  v_add_f32_dpp v87, v87, v87 row_mirror row_mask:0xf bank_mask:0xf
  v_mov_b32 v88, v86
  v_mov_b32 v89, v87
  s_nop 1
  v_permlane16_swap_b32 v86, v88
  v_permlane16_swap_b32 v87, v89
  s_nop 1
  v_add_f32 v86, v86, v88
  v_add_f32 v87, v87, v89
  v_mov_b32 v88, v86
  v_mov_b32 v89, v87
  s_nop 1
  v_permlane32_swap_b32 v86, v88
  v_permlane32_swap_b32 v87, v89
  s_nop 1
  v_add_f32 v86, v86, v88
  v_add_f32 v87, v87, v89
  v_mul_f32 v86, 0x3b000000, v86
  v_mul_f32 v87, 0x3b000000, v87
  v_sub_f32 v92, v48, v86
  v_mul_f32 v90, v92, v92
  v_sub_f32 v92, v49, v86
  v_fmac_f32 v90, v92, v92
  v_sub_f32 v92, v50, v86
  v_fmac_f32 v90, v92, v92
  v_sub_f32 v92, v51, v86
  v_fmac_f32 v90, v92, v92
  v_sub_f32 v92, v52, v86
  v_fmac_f32 v90, v92, v92
  v_sub_f32 v92, v53, v86
  v_fmac_f32 v90, v92, v92
  v_sub_f32 v92, v54, v86
  v_fmac_f32 v90, v92, v92
  v_sub_f32 v92, v55, v86
  v_fmac_f32 v90, v92, v92
  v_sub_f32 v92, v56, v87
  v_mul_f32 v91, v92, v92
  v_sub_f32 v92, v57, v87
  v_fmac_f32 v91, v92, v92
  v_sub_f32 v92, v58, v87
  v_fmac_f32 v91, v92, v92
  v_sub_f32 v92, v59, v87
  v_fmac_f32 v91, v92, v92
  v_sub_f32 v92, v60, v87
  v_fmac_f32 v91, v92, v92
  v_sub_f32 v92, v61, v87
  v_fmac_f32 v91, v92, v92
  v_sub_f32 v92, v62, v87
  v_fmac_f32 v91, v92, v92
  v_sub_f32 v92, v63, v87
  v_fmac_f32 v91, v92, v92
  s_nop 1
  v_add_f32_dpp v90, v90, v90 quad_perm:[1,0,3,2] row_mask:0xf bank_mask:0xf
  v_add_f32_dpp v91, v91, v91 quad_perm:[1,0,3,2] row_mask:0xf bank_mask:0xf
  s_nop 1
  v_add_f32_dpp v90, v90, v90 quad_perm:[2,3,0,1] row_mask:0xf bank_mask:0xf
  v_add_f32_dpp v91, v91, v91 quad_perm:[2,3,0,1] row_mask:0xf bank_mask:0xf
  s_nop 1
  v_add_f32_dpp v90, v90, v90 row_half_mirror row_mask:0xf bank_mask:0xf
  v_add_f32_dpp v91, v91, v91 row_half_mirror row_mask:0xf bank_mask:0xf
  s_nop 1
  v_add_f32_dpp v90, v90, v90 row_mirror row_mask:0xf bank_mask:0xf
  v_add_f32_dpp v91, v91, v91 row_mirror row_mask:0xf bank_mask:0xf
  v_mov_b32 v88, v90
  v_mov_b32 v89, v91
  s_nop 1
  v_permlane16_swap_b32 v90, v88
  v_permlane16_swap_b32 v91, v89
  s_nop 1
  v_add_f32 v90, v90, v88
  v_add_f32 v91, v91, v89
  v_mov_b32 v88, v90
  v_mov_b32 v89, v91
  s_nop 1
  v_permlane32_swap_b32 v90, v88
  v_permlane32_swap_b32 v91, v89
  s_nop 1
  v_add_f32 v90, v90, v88
  v_add_f32 v91, v91, v89
  v_mul_f32 v90, 0x3b000000, v90
  v_mul_f32 v91, 0x3b000000, v91
  v_cvt_pk_bf16_f32 v86, v86, v86
  v_and_b32 v86, s64, v86
  v_cvt_pk_bf16_f32 v90, v90, v90
  v_and_b32 v90, s64, v90
  v_add_f32 v90, 0x3727c5ac, v90
  v_cvt_pk_bf16_f32 v90, v90, v90
  v_and_b32 v90, s64, v90
  v_sqrt_f32 v90, v90
  s_nop 0
  v_cvt_pk_bf16_f32 v90, v90, v90
  v_and_b32 v90, s64, v90
  v_rcp_f32 v92, v90
  v_cvt_pk_bf16_f32 v87, v87, v87
  v_and_b32 v87, s64, v87
  v_cvt_pk_bf16_f32 v91, v91, v91
  v_and_b32 v91, s64, v91
  v_add_f32 v91, 0x3727c5ac, v91
  v_cvt_pk_bf16_f32 v91, v91, v91
  v_and_b32 v91, s64, v91
  v_sqrt_f32 v91, v91
  s_nop 0
  v_cvt_pk_bf16_f32 v91, v91, v91
  v_and_b32 v91, s64, v91
  v_rcp_f32 v93, v91
  s_nop 0
  v_sub_f32 v48, v48, v86
  v_cvt_pk_bf16_f32 v48, v48, v48
  v_and_b32 v48, s64, v48
  v_mul_f32 v94, v48, v92
  v_fma_f32 v96, -v94, v90, v48
  v_fma_f32 v48, v96, v92, v94
  v_cvt_pk_bf16_f32 v40, v48, v48
  v_sub_f32 v56, v56, v87
  v_cvt_pk_bf16_f32 v56, v56, v56
  v_and_b32 v56, s64, v56
  v_mul_f32 v95, v56, v93
  v_fma_f32 v97, -v95, v91, v56
  v_fma_f32 v56, v97, v93, v95
  v_cvt_pk_bf16_f32 v41, v56, v56
  v_sub_f32 v49, v49, v86
  v_cvt_pk_bf16_f32 v49, v49, v49
  v_and_b32 v49, s64, v49
  v_mul_f32 v94, v49, v92
  v_fma_f32 v96, -v94, v90, v49
  v_fma_f32 v49, v96, v92, v94
  v_cvt_pk_bf16_f32 v42, v49, v49
  v_sub_f32 v57, v57, v87
  v_cvt_pk_bf16_f32 v57, v57, v57
  v_and_b32 v57, s64, v57
  v_mul_f32 v95, v57, v93
  v_fma_f32 v97, -v95, v91, v57
  v_fma_f32 v57, v97, v93, v95
  v_cvt_pk_bf16_f32 v43, v57, v57
  v_sub_f32 v50, v50, v86
  v_cvt_pk_bf16_f32 v50, v50, v50
  v_and_b32 v50, s64, v50
  v_mul_f32 v94, v50, v92
  v_fma_f32 v96, -v94, v90, v50
  v_fma_f32 v50, v96, v92, v94
  v_cvt_pk_bf16_f32 v44, v50, v50
  v_sub_f32 v58, v58, v87
  v_cvt_pk_bf16_f32 v58, v58, v58
  v_and_b32 v58, s64, v58
  v_mul_f32 v95, v58, v93
  v_fma_f32 v97, -v95, v91, v58
  v_fma_f32 v58, v97, v93, v95
  v_cvt_pk_bf16_f32 v45, v58, v58
  v_sub_f32 v51, v51, v86
  v_cvt_pk_bf16_f32 v51, v51, v51
  v_and_b32 v51, s64, v51
  v_mul_f32 v94, v51, v92
  v_fma_f32 v96, -v94, v90, v51
  v_fma_f32 v51, v96, v92, v94
  v_cvt_pk_bf16_f32 v46, v51, v51
  v_sub_f32 v59, v59, v87
  v_cvt_pk_bf16_f32 v59, v59, v59
  v_and_b32 v59, s64, v59
  v_mul_f32 v95, v59, v93
  v_fma_f32 v97, -v95, v91, v59
  v_fma_f32 v59, v97, v93, v95
  v_cvt_pk_bf16_f32 v47, v59, v59
  v_lshlrev_b32 v98, 6, v3
  ds_write_b128 v98, v[40:43] offset:0
  ds_write_b128 v98, v[44:47] offset:16
  s_nop 1
  v_sub_f32 v52, v52, v86
  v_cvt_pk_bf16_f32 v52, v52, v52
  v_and_b32 v52, s64, v52
  v_mul_f32 v94, v52, v92
  v_fma_f32 v96, -v94, v90, v52
  v_fma_f32 v52, v96, v92, v94
  v_cvt_pk_bf16_f32 v40, v52, v52
  v_sub_f32 v60, v60, v87
  v_cvt_pk_bf16_f32 v60, v60, v60
  v_and_b32 v60, s64, v60
  v_mul_f32 v95, v60, v93
  v_fma_f32 v97, -v95, v91, v60
  v_fma_f32 v60, v97, v93, v95
  v_cvt_pk_bf16_f32 v41, v60, v60
  v_sub_f32 v53, v53, v86
  v_cvt_pk_bf16_f32 v53, v53, v53
  v_and_b32 v53, s64, v53
  v_mul_f32 v94, v53, v92
  v_fma_f32 v96, -v94, v90, v53
  v_fma_f32 v53, v96, v92, v94
  v_cvt_pk_bf16_f32 v42, v53, v53
  v_sub_f32 v61, v61, v87
  v_cvt_pk_bf16_f32 v61, v61, v61
  v_and_b32 v61, s64, v61
  v_mul_f32 v95, v61, v93
  v_fma_f32 v97, -v95, v91, v61
  v_fma_f32 v61, v97, v93, v95
  v_cvt_pk_bf16_f32 v43, v61, v61
  v_sub_f32 v54, v54, v86
  v_cvt_pk_bf16_f32 v54, v54, v54
  v_and_b32 v54, s64, v54
  v_mul_f32 v94, v54, v92
  v_fma_f32 v96, -v94, v90, v54
  v_fma_f32 v54, v96, v92, v94
  v_cvt_pk_bf16_f32 v44, v54, v54
  v_sub_f32 v62, v62, v87
  v_cvt_pk_bf16_f32 v62, v62, v62
  v_and_b32 v62, s64, v62
  v_mul_f32 v95, v62, v93
  v_fma_f32 v97, -v95, v91, v62
  v_fma_f32 v62, v97, v93, v95
  v_cvt_pk_bf16_f32 v45, v62, v62
  v_sub_f32 v55, v55, v86
  v_cvt_pk_bf16_f32 v55, v55, v55
  v_and_b32 v55, s64, v55
  v_mul_f32 v94, v55, v92
  v_fma_f32 v96, -v94, v90, v55
  v_fma_f32 v55, v96, v92, v94
  v_cvt_pk_bf16_f32 v46, v55, v55
  v_sub_f32 v63, v63, v87
  v_cvt_pk_bf16_f32 v63, v63, v63
  v_and_b32 v63, s64, v63
  v_mul_f32 v95, v63, v93
  v_fma_f32 v97, -v95, v91, v63
  v_fma_f32 v63, v97, v93, v95
  v_cvt_pk_bf16_f32 v47, v63, v63
  v_lshlrev_b32 v98, 6, v3
  ds_write_b128 v98, v[40:43] offset:32
  ds_write_b128 v98, v[44:47] offset:48
  s_nop 1
  s_waitcnt lgkmcnt(0)
L_ln_done:
  s_barrier
  buffer_load_dwordx4 v[8:11], v6, s[28:31], s46 offen offset:0 nt
  buffer_load_dwordx4 v[12:15], v6, s[28:31], s46 offen offset:1024 nt
  buffer_load_dwordx4 v[16:19], v6, s[28:31], s46 offen offset:2048 nt
  buffer_load_dwordx4 v[20:23], v6, s[28:31], s46 offen offset:3072 nt
  buffer_load_dwordx4 v[24:27], v6, s[28:31], s47 offen offset:0 nt
  buffer_load_dwordx4 v[28:31], v6, s[28:31], s47 offen offset:1024 nt
  buffer_load_dwordx4 v[32:35], v6, s[28:31], s47 offen offset:2048 nt
  buffer_load_dwordx4 v[36:39], v6, s[28:31], s47 offen offset:3072 nt
  buffer_load_dwordx4 v[40:43], v6, s[32:35], s46 offen offset:0 nt
  buffer_load_dwordx4 v[44:47], v6, s[32:35], s46 offen offset:1024 nt
  buffer_load_dwordx4 v[48:51], v6, s[32:35], s46 offen offset:2048 nt
  buffer_load_dwordx4 v[52:55], v6, s[32:35], s46 offen offset:3072 nt
  buffer_load_dwordx4 v[56:59], v6, s[32:35], s47 offen offset:0 nt
  buffer_load_dwordx4 v[60:63], v6, s[32:35], s47 offen offset:1024 nt
  buffer_load_dwordx4 v[64:67], v6, s[32:35], s47 offen offset:2048 nt
  buffer_load_dwordx4 v[68:71], v6, s[32:35], s47 offen offset:3072 nt
  v_mov_b32 v76, 0
  v_mov_b32 v77, 0
  v_mov_b32 v78, 0
  v_mov_b32 v79, 0
  v_mov_b32 v80, 0
  v_mov_b32 v81, 0
  v_mov_b32 v82, 0
  v_mov_b32 v83, 0
  v_mov_b32 v84, 0xff800000
  v_mov_b32 v85, 0
  v_lshlrev_b32 v117, 5, v4
  s_lshl_b32 s41, s63, 9
  v_add_u32 v117, s41, v117
  s_barrier
  ds_read_b128 v[94:97], v117 offset:4096
  ds_read_b128 v[98:101], v117 offset:4112
  ds_read_b128 v[102:105], v117 offset:5120
  ds_read_b128 v[106:109], v117 offset:5136
  s_waitcnt lgkmcnt(0)
  v_add_f32 v86, v94, v102
  v_add_f32 v87, v95, v103
  v_add_f32 v88, v96, v104
  v_add_f32 v89, v97, v105
  v_add_f32 v90, v98, v106
  v_add_f32 v91, v99, v107
  v_add_f32 v92, v100, v108
  v_add_f32 v93, v101, v109
  ds_read_b128 v[94:97], v117 offset:6144
  ds_read_b128 v[98:101], v117 offset:6160
  ds_read_b128 v[102:105], v117 offset:7168
  ds_read_b128 v[106:109], v117 offset:7184
  s_waitcnt lgkmcnt(0)
  v_add_f32 v94, v94, v102
  v_add_f32 v95, v95, v103
  v_add_f32 v96, v96, v104
  v_add_f32 v97, v97, v105
  v_add_f32 v98, v98, v106
  v_add_f32 v99, v99, v107
  v_add_f32 v100, v100, v108
  v_add_f32 v101, v101, v109
  v_add_f32 v86, v86, v94
  v_add_f32 v87, v87, v95
  v_add_f32 v88, v88, v96
  v_add_f32 v89, v89, v97
  v_add_f32 v90, v90, v98
  v_add_f32 v91, v91, v99
  v_add_f32 v92, v92, v100
  v_add_f32 v93, v93, v101
  v_cvt_pk_bf16_f32 v72, v86, v87
  v_cvt_pk_bf16_f32 v73, v88, v89
  v_cvt_pk_bf16_f32 v74, v90, v91
  v_cvt_pk_bf16_f32 v75, v92, v93
  s_mov_b32 s49, 18
L_sloop:
  s_waitcnt vmcnt(8)
  v_dot2_f32_bf16 v86, v8, v72, 0
  v_dot2_f32_bf16 v87, v12, v72, 0
  v_dot2_f32_bf16 v88, v16, v72, 0
  v_dot2_f32_bf16 v89, v20, v72, 0
  v_dot2_f32_bf16 v90, v24, v72, 0
  v_dot2_f32_bf16 v91, v28, v72, 0
  v_dot2_f32_bf16 v92, v32, v72, 0
  v_dot2_f32_bf16 v93, v36, v72, 0
  v_dot2_f32_bf16 v86, v9, v73, v86
  v_dot2_f32_bf16 v87, v13, v73, v87
  v_dot2_f32_bf16 v88, v17, v73, v88
  v_dot2_f32_bf16 v89, v21, v73, v89
  v_dot2_f32_bf16 v90, v25, v73, v90
  v_dot2_f32_bf16 v91, v29, v73, v91
  v_dot2_f32_bf16 v92, v33, v73, v92
  v_dot2_f32_bf16 v93, v37, v73, v93
  v_dot2_f32_bf16 v86, v10, v74, v86
  v_dot2_f32_bf16 v87, v14, v74, v87
  v_dot2_f32_bf16 v88, v18, v74, v88
  v_dot2_f32_bf16 v89, v22, v74, v89
  v_dot2_f32_bf16 v90, v26, v74, v90
  v_dot2_f32_bf16 v91, v30, v74, v91
  v_dot2_f32_bf16 v92, v34, v74, v92
  v_dot2_f32_bf16 v93, v38, v74, v93
  v_dot2_f32_bf16 v86, v11, v75, v86
  v_dot2_f32_bf16 v87, v15, v75, v87
  v_dot2_f32_bf16 v88, v19, v75, v88
  v_dot2_f32_bf16 v89, v23, v75, v89
  v_dot2_f32_bf16 v90, v27, v75, v90
  v_dot2_f32_bf16 v91, v31, v75, v91
  v_dot2_f32_bf16 v92, v35, v75, v92
  v_dot2_f32_bf16 v93, v39, v75, v93
  s_add_u32 s46, s46, 131072
  s_cmp_eq_u32 s49, 1
  s_cselect_b32 s46, s65, s46
  s_add_u32 s47, s46, 4096
  buffer_load_dwordx4 v[8:11], v6, s[28:31], s46 offen offset:0 nt
  buffer_load_dwordx4 v[12:15], v6, s[28:31], s46 offen offset:1024 nt
  buffer_load_dwordx4 v[16:19], v6, s[28:31], s46 offen offset:2048 nt
  buffer_load_dwordx4 v[20:23], v6, s[28:31], s46 offen offset:3072 nt
  buffer_load_dwordx4 v[24:27], v6, s[28:31], s47 offen offset:0 nt
  buffer_load_dwordx4 v[28:31], v6, s[28:31], s47 offen offset:1024 nt
  buffer_load_dwordx4 v[32:35], v6, s[28:31], s47 offen offset:2048 nt
  buffer_load_dwordx4 v[36:39], v6, s[28:31], s47 offen offset:3072 nt
  v_add_f32_dpp v86, v86, v86 quad_perm:[1,0,3,2] row_mask:0xf bank_mask:0xf
  v_add_f32_dpp v87, v87, v87 quad_perm:[1,0,3,2] row_mask:0xf bank_mask:0xf
  v_add_f32_dpp v88, v88, v88 quad_perm:[1,0,3,2] row_mask:0xf bank_mask:0xf
  v_add_f32_dpp v89, v89, v89 quad_perm:[1,0,3,2] row_mask:0xf bank_mask:0xf
  v_add_f32_dpp v90, v90, v90 quad_perm:[1,0,3,2] row_mask:0xf bank_mask:0xf
  v_add_f32_dpp v91, v91, v91 quad_perm:[1,0,3,2] row_mask:0xf bank_mask:0xf
  v_add_f32_dpp v92, v92, v92 quad_perm:[1,0,3,2] row_mask:0xf bank_mask:0xf
  v_add_f32_dpp v93, v93, v93 quad_perm:[1,0,3,2] row_mask:0xf bank_mask:0xf
  v_add_f32_dpp v86, v86, v86 quad_perm:[2,3,0,1] row_mask:0xf bank_mask:0xf
  v_add_f32_dpp v87, v87, v87 quad_perm:[2,3,0,1] row_mask:0xf bank_mask:0xf
  v_add_f32_dpp v88, v88, v88 quad_perm:[2,3,0,1] row_mask:0xf bank_mask:0xf
  v_add_f32_dpp v89, v89, v89 quad_perm:[2,3,0,1] row_mask:0xf bank_mask:0xf
  v_add_f32_dpp v90, v90, v90 quad_perm:[2,3,0,1] row_mask:0xf bank_mask:0xf
  v_add_f32_dpp v91, v91, v91 quad_perm:[2,3,0,1] row_mask:0xf bank_mask:0xf
  v_add_f32_dpp v92, v92, v92 quad_perm:[2,3,0,1] row_mask:0xf bank_mask:0xf
  v_add_f32_dpp v93, v93, v93 quad_perm:[2,3,0,1] row_mask:0xf bank_mask:0xf
  v_add_f32_dpp v86, v86, v86 row_half_mirror row_mask:0xf bank_mask:0xf
  v_add_f32_dpp v87, v87, v87 row_half_mirror row_mask:0xf bank_mask:0xf
  v_add_f32_dpp v88, v88, v88 row_half_mirror row_mask:0xf bank_mask:0xf
  v_add_f32_dpp v89, v89, v89 row_half_mirror row_mask:0xf bank_mask:0xf
  v_add_f32_dpp v90, v90, v90 row_half_mirror row_mask:0xf bank_mask:0xf
  v_add_f32_dpp v91, v91, v91 row_half_mirror row_mask:0xf bank_mask:0xf
  v_add_f32_dpp v92, v92, v92 row_half_mirror row_mask:0xf bank_mask:0xf
  v_add_f32_dpp v93, v93, v93 row_half_mirror row_mask:0xf bank_mask:0xf
  v_add_f32_dpp v86, v86, v86 row_mirror row_mask:0xf bank_mask:0xf
  v_add_f32_dpp v87, v87, v87 row_mirror row_mask:0xf bank_mask:0xf
  v_add_f32_dpp v88, v88, v88 row_mirror row_mask:0xf bank_mask:0xf
  v_add_f32_dpp v89, v89, v89 row_mirror row_mask:0xf bank_mask:0xf
  v_add_f32_dpp v90, v90, v90 row_mirror row_mask:0xf bank_mask:0xf
  v_add_f32_dpp v91, v91, v91 row_mirror row_mask:0xf bank_mask:0xf
  v_add_f32_dpp v92, v92, v92 row_mirror row_mask:0xf bank_mask:0xf
  v_add_f32_dpp v93, v93, v93 row_mirror row_mask:0xf bank_mask:0xf
  v_cvt_pk_bf16_f32 v94, v86, v87
  v_cvt_pk_bf16_f32 v96, v88, v89
  v_cvt_pk_bf16_f32 v98, v90, v91
  v_cvt_pk_bf16_f32 v100, v92, v93
  v_lshlrev_b32 v86, 16, v94
  v_and_b32 v87, s64, v94
  v_lshlrev_b32 v88, 16, v96
  v_and_b32 v89, s64, v96
  v_lshlrev_b32 v90, 16, v98
  v_and_b32 v91, s64, v98
  v_lshlrev_b32 v92, 16, v100
  v_and_b32 v93, s64, v100
  v_mul_f32 v86, s51, v86
  v_mul_f32 v87, s51, v87
  v_mul_f32 v88, s51, v88
  v_mul_f32 v89, s51, v89
  v_mul_f32 v90, s51, v90
  v_mul_f32 v91, s51, v91
  v_mul_f32 v92, s51, v92
  v_mul_f32 v93, s51, v93
  v_cvt_pk_bf16_f32 v94, v86, v87
  v_cvt_pk_bf16_f32 v96, v88, v89
  v_cvt_pk_bf16_f32 v98, v90, v91
  v_cvt_pk_bf16_f32 v100, v92, v93
  v_lshlrev_b32 v86, 16, v94
  v_and_b32 v87, s64, v94
  v_lshlrev_b32 v88, 16, v96
  v_and_b32 v89, s64, v96
  v_lshlrev_b32 v90, 16, v98
  v_and_b32 v91, s64, v98
  v_lshlrev_b32 v92, 16, v100
  v_and_b32 v93, s64, v100
  v_max3_f32 v110, v86, v87, v84
  v_max3_f32 v110, v88, v89, v110
  v_max3_f32 v110, v90, v91, v110
  v_max3_f32 v110, v92, v93, v110
  v_mul_f32 v111, s50, v110
  v_fma_f32 v112, v84, s50, -v111
  v_mov_b32 v84, v110
  v_fma_f32 v86, v86, s50, -v111
  v_fma_f32 v87, v87, s50, -v111
  v_fma_f32 v88, v88, s50, -v111
  v_fma_f32 v89, v89, s50, -v111
  v_fma_f32 v90, v90, s50, -v111
  v_fma_f32 v91, v91, s50, -v111
  v_fma_f32 v92, v92, s50, -v111
  v_fma_f32 v93, v93, s50, -v111
  v_exp_f32 v112, v112
  v_exp_f32 v86, v86
  v_exp_f32 v87, v87
  v_exp_f32 v88, v88
  v_exp_f32 v89, v89
  v_exp_f32 v90, v90
  v_exp_f32 v91, v91
  v_exp_f32 v92, v92
  v_exp_f32 v93, v93
  v_mul_f32 v85, v85, v112
  v_mul_f32 v76, v76, v112
  v_mul_f32 v77, v77, v112
  v_mul_f32 v78, v78, v112
  v_mul_f32 v79, v79, v112
  v_mul_f32 v80, v80, v112
  v_mul_f32 v81, v81, v112
  v_mul_f32 v82, v82, v112
  v_mul_f32 v83, v83, v112
  v_cvt_pk_bf16_f32 v94, v86, 0
  v_cvt_pk_bf16_f32 v95, v87, 0
  v_cvt_pk_bf16_f32 v96, v88, 0
  v_cvt_pk_bf16_f32 v97, v89, 0
  v_cvt_pk_bf16_f32 v98, v90, 0
  v_cvt_pk_bf16_f32 v99, v91, 0
  v_cvt_pk_bf16_f32 v100, v92, 0
  v_cvt_pk_bf16_f32 v101, v93, 0
  v_add_f32 v85, v85, v86
  v_add_f32 v85, v85, v87
  v_add_f32 v85, v85, v88
  v_add_f32 v85, v85, v89
  v_add_f32 v85, v85, v90
  v_add_f32 v85, v85, v91
  v_add_f32 v85, v85, v92
  v_add_f32 v85, v85, v93
  v_lshlrev_b32 v102, 16, v94
  v_lshlrev_b32 v103, 16, v95
  v_lshlrev_b32 v104, 16, v96
  v_lshlrev_b32 v105, 16, v97
  v_lshlrev_b32 v106, 16, v98
  v_lshlrev_b32 v107, 16, v99
  v_lshlrev_b32 v108, 16, v100
  v_lshlrev_b32 v109, 16, v101
  s_waitcnt vmcnt(8)
  v_dot2_f32_bf16 v76, v40, v94, v76
  v_dot2_f32_bf16 v77, v40, v102, v77
  v_dot2_f32_bf16 v78, v41, v94, v78
  v_dot2_f32_bf16 v79, v41, v102, v79
  v_dot2_f32_bf16 v80, v42, v94, v80
  v_dot2_f32_bf16 v81, v42, v102, v81
  v_dot2_f32_bf16 v82, v43, v94, v82
  v_dot2_f32_bf16 v83, v43, v102, v83
  v_dot2_f32_bf16 v76, v44, v95, v76
  v_dot2_f32_bf16 v77, v44, v103, v77
  v_dot2_f32_bf16 v78, v45, v95, v78
  v_dot2_f32_bf16 v79, v45, v103, v79
  v_dot2_f32_bf16 v80, v46, v95, v80
  v_dot2_f32_bf16 v81, v46, v103, v81
  v_dot2_f32_bf16 v82, v47, v95, v82
  v_dot2_f32_bf16 v83, v47, v103, v83
  v_dot2_f32_bf16 v76, v48, v96, v76
  v_dot2_f32_bf16 v77, v48, v104, v77
  v_dot2_f32_bf16 v78, v49, v96, v78
  v_dot2_f32_bf16 v79, v49, v104, v79
  v_dot2_f32_bf16 v80, v50, v96, v80
  v_dot2_f32_bf16 v81, v50, v104, v81
  v_dot2_f32_bf16 v82, v51, v96, v82
  v_dot2_f32_bf16 v83, v51, v104, v83
  v_dot2_f32_bf16 v76, v52, v97, v76
  v_dot2_f32_bf16 v77, v52, v105, v77
  v_dot2_f32_bf16 v78, v53, v97, v78
  v_dot2_f32_bf16 v79, v53, v105, v79
  v_dot2_f32_bf16 v80, v54, v97, v80
  v_dot2_f32_bf16 v81, v54, v105, v81
  v_dot2_f32_bf16 v82, v55, v97, v82
  v_dot2_f32_bf16 v83, v55, v105, v83
  v_dot2_f32_bf16 v76, v56, v98, v76
  v_dot2_f32_bf16 v77, v56, v106, v77
  v_dot2_f32_bf16 v78, v57, v98, v78
  v_dot2_f32_bf16 v79, v57, v106, v79
  v_dot2_f32_bf16 v80, v58, v98, v80
  v_dot2_f32_bf16 v81, v58, v106, v81
  v_dot2_f32_bf16 v82, v59, v98, v82
  v_dot2_f32_bf16 v83, v59, v106, v83
  v_dot2_f32_bf16 v76, v60, v99, v76
  v_dot2_f32_bf16 v77, v60, v107, v77
  v_dot2_f32_bf16 v78, v61, v99, v78
  v_dot2_f32_bf16 v79, v61, v107, v79
  v_dot2_f32_bf16 v80, v62, v99, v80
  v_dot2_f32_bf16 v81, v62, v107, v81
  v_dot2_f32_bf16 v82, v63, v99, v82
  v_dot2_f32_bf16 v83, v63, v107, v83
  v_dot2_f32_bf16 v76, v64, v100, v76
  v_dot2_f32_bf16 v77, v64, v108, v77
  v_dot2_f32_bf16 v78, v65, v100, v78
  v_dot2_f32_bf16 v79, v65, v108, v79
  v_dot2_f32_bf16 v80, v66, v100, v80
  v_dot2_f32_bf16 v81, v66, v108, v81
  v_dot2_f32_bf16 v82, v67, v100, v82
  v_dot2_f32_bf16 v83, v67, v108, v83
  v_dot2_f32_bf16 v76, v68, v101, v76
  v_dot2_f32_bf16 v77, v68, v109, v77
  v_dot2_f32_bf16 v78, v69, v101, v78
  v_dot2_f32_bf16 v79, v69, v109, v79
  v_dot2_f32_bf16 v80, v70, v101, v80
  v_dot2_f32_bf16 v81, v70, v109, v81
  v_dot2_f32_bf16 v82, v71, v101, v82
  v_dot2_f32_bf16 v83, v71, v109, v83
  buffer_load_dwordx4 v[40:43], v6, s[32:35], s46 offen offset:0 nt
  buffer_load_dwordx4 v[44:47], v6, s[32:35], s46 offen offset:1024 nt
  buffer_load_dwordx4 v[48:51], v6, s[32:35], s46 offen offset:2048 nt
  buffer_load_dwordx4 v[52:55], v6, s[32:35], s46 offen offset:3072 nt
  buffer_load_dwordx4 v[56:59], v6, s[32:35], s47 offen offset:0 nt
  buffer_load_dwordx4 v[60:63], v6, s[32:35], s47 offen offset:1024 nt
  buffer_load_dwordx4 v[64:67], v6, s[32:35], s47 offen offset:2048 nt
  buffer_load_dwordx4 v[68:71], v6, s[32:35], s47 offen offset:3072 nt
  s_cmp_lg_u32 s49, 5
  s_cbranch_scc1 L_noprog
  v_mov_b32 v117, 21580
  v_mov_b32 v110, 1
  s_mov_b64 exec, 1
  ds_add_u32 v117, v110
  s_mov_b64 exec, -1
L_noprog:
  s_sub_u32 s49, s49, 1
  s_cmp_lg_u32 s49, 0
  s_cbranch_scc1 L_sloop
  s_branch L_dump
L_phase2:
  v_mov_b32 v76, 0
  v_mov_b32 v77, 0
  v_mov_b32 v78, 0
  v_mov_b32 v79, 0
  v_mov_b32 v80, 0
  v_mov_b32 v81, 0
  v_mov_b32 v82, 0
  v_mov_b32 v83, 0
  v_mov_b32 v84, 0xff800000
  v_mov_b32 v85, 0
  v_mov_b32 v117, 21576
  s_mov_b32 s62, 1048576
L_pq2:
  ds_read_b32 v110, v117
  s_waitcnt lgkmcnt(0)
  v_readfirstlane_b32 s41, v110
  s_sub_u32 s62, s62, 1
  s_cmp_eq_u32 s62, 0
  s_cbranch_scc1 L_pq2_done
  s_cmp_ge_u32 s41, 1
  s_cbranch_scc1 L_pq2_done
  s_sleep 4
  s_branch L_pq2
L_pq2_done:
  v_lshlrev_b32 v117, 4, v4
  s_lshl_b32 s41, s63, 8
  v_add_u32 v117, s41, v117
  ds_read_b128 v[72:75], v117 offset:12288
  s_add_u32 s48, s67, 16
  s_sub_u32 s48, s48, 320
  v_mov_b32 v114, s48
  s_mov_b32 s49, 0
  s_waitcnt lgkmcnt(0)
L_dloop:
  s_waitcnt vmcnt(8)
  v_dot2_f32_bf16 v86, v8, v72, 0
  v_dot2_f32_bf16 v87, v12, v72, 0
  v_dot2_f32_bf16 v88, v16, v72, 0
  v_dot2_f32_bf16 v89, v20, v72, 0
  v_dot2_f32_bf16 v90, v24, v72, 0
  v_dot2_f32_bf16 v91, v28, v72, 0
  v_dot2_f32_bf16 v92, v32, v72, 0
  v_dot2_f32_bf16 v93, v36, v72, 0
  v_dot2_f32_bf16 v86, v9, v73, v86
  v_dot2_f32_bf16 v87, v13, v73, v87
  v_dot2_f32_bf16 v88, v17, v73, v88
  v_dot2_f32_bf16 v89, v21, v73, v89
  v_dot2_f32_bf16 v90, v25, v73, v90
  v_dot2_f32_bf16 v91, v29, v73, v91
  v_dot2_f32_bf16 v92, v33, v73, v92
  v_dot2_f32_bf16 v93, v37, v73, v93
  v_dot2_f32_bf16 v86, v10, v74, v86
  v_dot2_f32_bf16 v87, v14, v74, v87
  v_dot2_f32_bf16 v88, v18, v74, v88
  v_dot2_f32_bf16 v89, v22, v74, v89
  v_dot2_f32_bf16 v90, v26, v74, v90
  v_dot2_f32_bf16 v91, v30, v74, v91
  v_dot2_f32_bf16 v92, v34, v74, v92
  v_dot2_f32_bf16 v93, v38, v74, v93
  v_dot2_f32_bf16 v86, v11, v75, v86
  v_dot2_f32_bf16 v87, v15, v75, v87
  v_dot2_f32_bf16 v88, v19, v75, v88
  v_dot2_f32_bf16 v89, v23, v75, v89
  v_dot2_f32_bf16 v90, v27, v75, v90
  v_dot2_f32_bf16 v91, v31, v75, v91
  v_dot2_f32_bf16 v92, v35, v75, v92
  v_dot2_f32_bf16 v93, v39, v75, v93
  v_readfirstlane_b32 s48, v114
  s_nop 3
  s_add_u32 s48, s48, 320
  s_cmp_lt_u32 s48, 448
  s_cbranch_scc1 L_notnear
  s_cmp_lg_u32 s49, 0
  s_cbranch_scc1 L_notnear2
  s_mov_b32 s49, 1
  v_mov_b32 v117, 21584
  v_mov_b32 v110, 1
  s_mov_b64 exec, 1
  ds_add_u32 v117, v110
  s_mov_b64 exec, -1
L_notnear2:
  s_cmp_ge_u32 s48, 512
  s_cbranch_scc1 L_last
L_notnear:
  s_mul_i32 s46, s48, 8192
  s_add_u32 s46, s46, s55
  s_add_u32 s47, s46, 4096
  buffer_load_dwordx4 v[8:11], v6, s[28:31], s46 offen offset:0 nt
  buffer_load_dwordx4 v[12:15], v6, s[28:31], s46 offen offset:1024 nt
  buffer_load_dwordx4 v[16:19], v6, s[28:31], s46 offen offset:2048 nt
  buffer_load_dwordx4 v[20:23], v6, s[28:31], s46 offen offset:3072 nt
  buffer_load_dwordx4 v[24:27], v6, s[28:31], s47 offen offset:0 nt
  buffer_load_dwordx4 v[28:31], v6, s[28:31], s47 offen offset:1024 nt
  buffer_load_dwordx4 v[32:35], v6, s[28:31], s47 offen offset:2048 nt
  buffer_load_dwordx4 v[36:39], v6, s[28:31], s47 offen offset:3072 nt
  s_mov_b64 exec, 1
  v_mov_b32 v114, 1
  global_atomic_add v114, v115, v114, s[26:27] sc0 sc1
  s_mov_b64 exec, -1
  v_add_f32_dpp v86, v86, v86 quad_perm:[1,0,3,2] row_mask:0xf bank_mask:0xf
  v_add_f32_dpp v87, v87, v87 quad_perm:[1,0,3,2] row_mask:0xf bank_mask:0xf
  v_add_f32_dpp v88, v88, v88 quad_perm:[1,0,3,2] row_mask:0xf bank_mask:0xf
  v_add_f32_dpp v89, v89, v89 quad_perm:[1,0,3,2] row_mask:0xf bank_mask:0xf
  v_add_f32_dpp v90, v90, v90 quad_perm:[1,0,3,2] row_mask:0xf bank_mask:0xf
  v_add_f32_dpp v91, v91, v91 quad_perm:[1,0,3,2] row_mask:0xf bank_mask:0xf
  v_add_f32_dpp v92, v92, v92 quad_perm:[1,0,3,2] row_mask:0xf bank_mask:0xf
  v_add_f32_dpp v93, v93, v93 quad_perm:[1,0,3,2] row_mask:0xf bank_mask:0xf
  v_add_f32_dpp v86, v86, v86 quad_perm:[2,3,0,1] row_mask:0xf bank_mask:0xf
  v_add_f32_dpp v87, v87, v87 quad_perm:[2,3,0,1] row_mask:0xf bank_mask:0xf
  v_add_f32_dpp v88, v88, v88 quad_perm:[2,3,0,1] row_mask:0xf bank_mask:0xf
  v_add_f32_dpp v89, v89, v89 quad_perm:[2,3,0,1] row_mask:0xf bank_mask:0xf
  v_add_f32_dpp v90, v90, v90 quad_perm:[2,3,0,1] row_mask:0xf bank_mask:0xf
  v_add_f32_dpp v91, v91, v91 quad_perm:[2,3,0,1] row_mask:0xf bank_mask:0xf
  v_add_f32_dpp v92, v92, v92 quad_perm:[2,3,0,1] row_mask:0xf bank_mask:0xf
  v_add_f32_dpp v93, v93, v93 quad_perm:[2,3,0,1] row_mask:0xf bank_mask:0xf
  v_add_f32_dpp v86, v86, v86 row_half_mirror row_mask:0xf bank_mask:0xf
  v_add_f32_dpp v87, v87, v87 row_half_mirror row_mask:0xf bank_mask:0xf
  v_add_f32_dpp v88, v88, v88 row_half_mirror row_mask:0xf bank_mask:0xf
  v_add_f32_dpp v89, v89, v89 row_half_mirror row_mask:0xf bank_mask:0xf
  v_add_f32_dpp v90, v90, v90 row_half_mirror row_mask:0xf bank_mask:0xf
  v_add_f32_dpp v91, v91, v91 row_half_mirror row_mask:0xf bank_mask:0xf
  v_add_f32_dpp v92, v92, v92 row_half_mirror row_mask:0xf bank_mask:0xf
  v_add_f32_dpp v93, v93, v93 row_half_mirror row_mask:0xf bank_mask:0xf
  v_add_f32_dpp v86, v86, v86 row_mirror row_mask:0xf bank_mask:0xf
  v_add_f32_dpp v87, v87, v87 row_mirror row_mask:0xf bank_mask:0xf
  v_add_f32_dpp v88, v88, v88 row_mirror row_mask:0xf bank_mask:0xf
  v_add_f32_dpp v89, v89, v89 row_mirror row_mask:0xf bank_mask:0xf
  v_add_f32_dpp v90, v90, v90 row_mirror row_mask:0xf bank_mask:0xf
  v_add_f32_dpp v91, v91, v91 row_mirror row_mask:0xf bank_mask:0xf
  v_add_f32_dpp v92, v92, v92 row_mirror row_mask:0xf bank_mask:0xf
  v_add_f32_dpp v93, v93, v93 row_mirror row_mask:0xf bank_mask:0xf
  v_cvt_pk_bf16_f32 v94, v86, v87
  v_cvt_pk_bf16_f32 v96, v88, v89
  v_cvt_pk_bf16_f32 v98, v90, v91
  v_cvt_pk_bf16_f32 v100, v92, v93
  v_lshlrev_b32 v86, 16, v94
  v_and_b32 v87, s64, v94
  v_lshlrev_b32 v88, 16, v96
  v_and_b32 v89, s64, v96
  v_lshlrev_b32 v90, 16, v98
  v_and_b32 v91, s64, v98
  v_lshlrev_b32 v92, 16, v100
  v_and_b32 v93, s64, v100
  v_mul_f32 v86, s51, v86
  v_mul_f32 v87, s51, v87
  v_mul_f32 v88, s51, v88
  v_mul_f32 v89, s51, v89
  v_mul_f32 v90, s51, v90
  v_mul_f32 v91, s51, v91
  v_mul_f32 v92, s51, v92
  v_mul_f32 v93, s51, v93
  v_cvt_pk_bf16_f32 v94, v86, v87
  v_cvt_pk_bf16_f32 v96, v88, v89
  v_cvt_pk_bf16_f32 v98, v90, v91
  v_cvt_pk_bf16_f32 v100, v92, v93
  v_lshlrev_b32 v86, 16, v94
  v_and_b32 v87, s64, v94
  v_lshlrev_b32 v88, 16, v96
  v_and_b32 v89, s64, v96
  v_lshlrev_b32 v90, 16, v98
  v_and_b32 v91, s64, v98
  v_lshlrev_b32 v92, 16, v100
  v_and_b32 v93, s64, v100
  v_max3_f32 v110, v86, v87, v84
  v_max3_f32 v110, v88, v89, v110
  v_max3_f32 v110, v90, v91, v110
  v_max3_f32 v110, v92, v93, v110
  v_mul_f32 v111, s50, v110
  v_fma_f32 v112, v84, s50, -v111
  v_mov_b32 v84, v110
  v_fma_f32 v86, v86, s50, -v111
  v_fma_f32 v87, v87, s50, -v111
  v_fma_f32 v88, v88, s50, -v111
  v_fma_f32 v89, v89, s50, -v111
  v_fma_f32 v90, v90, s50, -v111
  v_fma_f32 v91, v91, s50, -v111
  v_fma_f32 v92, v92, s50, -v111
  v_fma_f32 v93, v93, s50, -v111
  v_exp_f32 v112, v112
  v_exp_f32 v86, v86
  v_exp_f32 v87, v87
  v_exp_f32 v88, v88
  v_exp_f32 v89, v89
  v_exp_f32 v90, v90
  v_exp_f32 v91, v91
  v_exp_f32 v92, v92
  v_exp_f32 v93, v93
  v_mul_f32 v85, v85, v112
  v_mul_f32 v76, v76, v112
  v_mul_f32 v77, v77, v112
  v_mul_f32 v78, v78, v112
  v_mul_f32 v79, v79, v112
  v_mul_f32 v80, v80, v112
  v_mul_f32 v81, v81, v112
  v_mul_f32 v82, v82, v112
  v_mul_f32 v83, v83, v112
  v_cvt_pk_bf16_f32 v94, v86, 0
  v_cvt_pk_bf16_f32 v95, v87, 0
  v_cvt_pk_bf16_f32 v96, v88, 0
  v_cvt_pk_bf16_f32 v97, v89, 0
  v_cvt_pk_bf16_f32 v98, v90, 0
  v_cvt_pk_bf16_f32 v99, v91, 0
  v_cvt_pk_bf16_f32 v100, v92, 0
  v_cvt_pk_bf16_f32 v101, v93, 0
  v_add_f32 v85, v85, v86
  v_add_f32 v85, v85, v87
  v_add_f32 v85, v85, v88
  v_add_f32 v85, v85, v89
  v_add_f32 v85, v85, v90
  v_add_f32 v85, v85, v91
  v_add_f32 v85, v85, v92
  v_add_f32 v85, v85, v93
  v_lshlrev_b32 v102, 16, v94
  v_lshlrev_b32 v103, 16, v95
  v_lshlrev_b32 v104, 16, v96
  v_lshlrev_b32 v105, 16, v97
  v_lshlrev_b32 v106, 16, v98
  v_lshlrev_b32 v107, 16, v99
  v_lshlrev_b32 v108, 16, v100
  v_lshlrev_b32 v109, 16, v101
  s_waitcnt vmcnt(9)
  v_dot2_f32_bf16 v76, v40, v94, v76
  v_dot2_f32_bf16 v77, v40, v102, v77
  v_dot2_f32_bf16 v78, v41, v94, v78
  v_dot2_f32_bf16 v79, v41, v102, v79
  v_dot2_f32_bf16 v80, v42, v94, v80
  v_dot2_f32_bf16 v81, v42, v102, v81
  v_dot2_f32_bf16 v82, v43, v94, v82
  v_dot2_f32_bf16 v83, v43, v102, v83
  v_dot2_f32_bf16 v76, v44, v95, v76
  v_dot2_f32_bf16 v77, v44, v103, v77
  v_dot2_f32_bf16 v78, v45, v95, v78
  v_dot2_f32_bf16 v79, v45, v103, v79
  v_dot2_f32_bf16 v80, v46, v95, v80
  v_dot2_f32_bf16 v81, v46, v103, v81
  v_dot2_f32_bf16 v82, v47, v95, v82
  v_dot2_f32_bf16 v83, v47, v103, v83
  v_dot2_f32_bf16 v76, v48, v96, v76
  v_dot2_f32_bf16 v77, v48, v104, v77
  v_dot2_f32_bf16 v78, v49, v96, v78
  v_dot2_f32_bf16 v79, v49, v104, v79
  v_dot2_f32_bf16 v80, v50, v96, v80
  v_dot2_f32_bf16 v81, v50, v104, v81
  v_dot2_f32_bf16 v82, v51, v96, v82
  v_dot2_f32_bf16 v83, v51, v104, v83
  v_dot2_f32_bf16 v76, v52, v97, v76
  v_dot2_f32_bf16 v77, v52, v105, v77
  v_dot2_f32_bf16 v78, v53, v97, v78
  v_dot2_f32_bf16 v79, v53, v105, v79
  v_dot2_f32_bf16 v80, v54, v97, v80
  v_dot2_f32_bf16 v81, v54, v105, v81
  v_dot2_f32_bf16 v82, v55, v97, v82
  v_dot2_f32_bf16 v83, v55, v105, v83
  v_dot2_f32_bf16 v76, v56, v98, v76
  v_dot2_f32_bf16 v77, v56, v106, v77
  v_dot2_f32_bf16 v78, v57, v98, v78
  v_dot2_f32_bf16 v79, v57, v106, v79
  v_dot2_f32_bf16 v80, v58, v98, v80
  v_dot2_f32_bf16 v81, v58, v106, v81
  v_dot2_f32_bf16 v82, v59, v98, v82
  v_dot2_f32_bf16 v83, v59, v106, v83
  v_dot2_f32_bf16 v76, v60, v99, v76
  v_dot2_f32_bf16 v77, v60, v107, v77
  v_dot2_f32_bf16 v78, v61, v99, v78
  v_dot2_f32_bf16 v79, v61, v107, v79
  v_dot2_f32_bf16 v80, v62, v99, v80
  v_dot2_f32_bf16 v81, v62, v107, v81
  v_dot2_f32_bf16 v82, v63, v99, v82
  v_dot2_f32_bf16 v83, v63, v107, v83
  v_dot2_f32_bf16 v76, v64, v100, v76
  v_dot2_f32_bf16 v77, v64, v108, v77
  v_dot2_f32_bf16 v78, v65, v100, v78
  v_dot2_f32_bf16 v79, v65, v108, v79
  v_dot2_f32_bf16 v80, v66, v100, v80
  v_dot2_f32_bf16 v81, v66, v108, v81
  v_dot2_f32_bf16 v82, v67, v100, v82
  v_dot2_f32_bf16 v83, v67, v108, v83
  v_dot2_f32_bf16 v76, v68, v101, v76
  v_dot2_f32_bf16 v77, v68, v109, v77
  v_dot2_f32_bf16 v78, v69, v101, v78
  v_dot2_f32_bf16 v79, v69, v109, v79
  v_dot2_f32_bf16 v80, v70, v101, v80
  v_dot2_f32_bf16 v81, v70, v109, v81
  v_dot2_f32_bf16 v82, v71, v101, v82
  v_dot2_f32_bf16 v83, v71, v109, v83
  buffer_load_dwordx4 v[40:43], v6, s[32:35], s46 offen offset:0 nt
  buffer_load_dwordx4 v[44:47], v6, s[32:35], s46 offen offset:1024 nt
  buffer_load_dwordx4 v[48:51], v6, s[32:35], s46 offen offset:2048 nt
  buffer_load_dwordx4 v[52:55], v6, s[32:35], s46 offen offset:3072 nt
  buffer_load_dwordx4 v[56:59], v6, s[32:35], s47 offen offset:0 nt
  buffer_load_dwordx4 v[60:63], v6, s[32:35], s47 offen offset:1024 nt
  buffer_load_dwordx4 v[64:67], v6, s[32:35], s47 offen offset:2048 nt
  buffer_load_dwordx4 v[68:71], v6, s[32:35], s47 offen offset:3072 nt
  s_branch L_dloop
L_last:
  v_add_f32_dpp v86, v86, v86 quad_perm:[1,0,3,2] row_mask:0xf bank_mask:0xf
  v_add_f32_dpp v87, v87, v87 quad_perm:[1,0,3,2] row_mask:0xf bank_mask:0xf
  v_add_f32_dpp v88, v88, v88 quad_perm:[1,0,3,2] row_mask:0xf bank_mask:0xf
  v_add_f32_dpp v89, v89, v89 quad_perm:[1,0,3,2] row_mask:0xf bank_mask:0xf
  v_add_f32_dpp v90, v90, v90 quad_perm:[1,0,3,2] row_mask:0xf bank_mask:0xf
  v_add_f32_dpp v91, v91, v91 quad_perm:[1,0,3,2] row_mask:0xf bank_mask:0xf
  v_add_f32_dpp v92, v92, v92 quad_perm:[1,0,3,2] row_mask:0xf bank_mask:0xf
  v_add_f32_dpp v93, v93, v93 quad_perm:[1,0,3,2] row_mask:0xf bank_mask:0xf
  v_add_f32_dpp v86, v86, v86 quad_perm:[2,3,0,1] row_mask:0xf bank_mask:0xf
  v_add_f32_dpp v87, v87, v87 quad_perm:[2,3,0,1] row_mask:0xf bank_mask:0xf
  v_add_f32_dpp v88, v88, v88 quad_perm:[2,3,0,1] row_mask:0xf bank_mask:0xf
  v_add_f32_dpp v89, v89, v89 quad_perm:[2,3,0,1] row_mask:0xf bank_mask:0xf
  v_add_f32_dpp v90, v90, v90 quad_perm:[2,3,0,1] row_mask:0xf bank_mask:0xf
  v_add_f32_dpp v91, v91, v91 quad_perm:[2,3,0,1] row_mask:0xf bank_mask:0xf
  v_add_f32_dpp v92, v92, v92 quad_perm:[2,3,0,1] row_mask:0xf bank_mask:0xf
  v_add_f32_dpp v93, v93, v93 quad_perm:[2,3,0,1] row_mask:0xf bank_mask:0xf
  v_add_f32_dpp v86, v86, v86 row_half_mirror row_mask:0xf bank_mask:0xf
  v_add_f32_dpp v87, v87, v87 row_half_mirror row_mask:0xf bank_mask:0xf
  v_add_f32_dpp v88, v88, v88 row_half_mirror row_mask:0xf bank_mask:0xf
  v_add_f32_dpp v89, v89, v89 row_half_mirror row_mask:0xf bank_mask:0xf
  v_add_f32_dpp v90, v90, v90 row_half_mirror row_mask:0xf bank_mask:0xf
  v_add_f32_dpp v91, v91, v91 row_half_mirror row_mask:0xf bank_mask:0xf
  v_add_f32_dpp v92, v92, v92 row_half_mirror row_mask:0xf bank_mask:0xf
  v_add_f32_dpp v93, v93, v93 row_half_mirror row_mask:0xf bank_mask:0xf
  v_add_f32_dpp v86, v86, v86 row_mirror row_mask:0xf bank_mask:0xf
  v_add_f32_dpp v87, v87, v87 row_mirror row_mask:0xf bank_mask:0xf
  v_add_f32_dpp v88, v88, v88 row_mirror row_mask:0xf bank_mask:0xf
  v_add_f32_dpp v89, v89, v89 row_mirror row_mask:0xf bank_mask:0xf
  v_add_f32_dpp v90, v90, v90 row_mirror row_mask:0xf bank_mask:0xf
  v_add_f32_dpp v91, v91, v91 row_mirror row_mask:0xf bank_mask:0xf
  v_add_f32_dpp v92, v92, v92 row_mirror row_mask:0xf bank_mask:0xf
  v_add_f32_dpp v93, v93, v93 row_mirror row_mask:0xf bank_mask:0xf
  v_cvt_pk_bf16_f32 v94, v86, v87
  v_cvt_pk_bf16_f32 v96, v88, v89
  v_cvt_pk_bf16_f32 v98, v90, v91
  v_cvt_pk_bf16_f32 v100, v92, v93
  v_lshlrev_b32 v86, 16, v94
  v_and_b32 v87, s64, v94
  v_lshlrev_b32 v88, 16, v96
  v_and_b32 v89, s64, v96
  v_lshlrev_b32 v90, 16, v98
  v_and_b32 v91, s64, v98
  v_lshlrev_b32 v92, 16, v100
  v_and_b32 v93, s64, v100
  v_mul_f32 v86, s51, v86
  v_mul_f32 v87, s51, v87
  v_mul_f32 v88, s51, v88
  v_mul_f32 v89, s51, v89
  v_mul_f32 v90, s51, v90
  v_mul_f32 v91, s51, v91
  v_mul_f32 v92, s51, v92
  v_mul_f32 v93, s51, v93
  v_cvt_pk_bf16_f32 v94, v86, v87
  v_cvt_pk_bf16_f32 v96, v88, v89
  v_cvt_pk_bf16_f32 v98, v90, v91
  v_cvt_pk_bf16_f32 v100, v92, v93
  v_lshlrev_b32 v86, 16, v94
  v_and_b32 v87, s64, v94
  v_lshlrev_b32 v88, 16, v96
  v_and_b32 v89, s64, v96
  v_lshlrev_b32 v90, 16, v98
  v_and_b32 v91, s64, v98
  v_lshlrev_b32 v92, 16, v100
  v_and_b32 v93, s64, v100
  v_max3_f32 v110, v86, v87, v84
  v_max3_f32 v110, v88, v89, v110
  v_max3_f32 v110, v90, v91, v110
  v_max3_f32 v110, v92, v93, v110
  v_mul_f32 v111, s50, v110
  v_fma_f32 v112, v84, s50, -v111
  v_mov_b32 v84, v110
  v_fma_f32 v86, v86, s50, -v111
  v_fma_f32 v87, v87, s50, -v111
  v_fma_f32 v88, v88, s50, -v111
  v_fma_f32 v89, v89, s50, -v111
  v_fma_f32 v90, v90, s50, -v111
  v_fma_f32 v91, v91, s50, -v111
  v_fma_f32 v92, v92, s50, -v111
  v_fma_f32 v93, v93, s50, -v111
  v_exp_f32 v112, v112
  v_exp_f32 v86, v86
  v_exp_f32 v87, v87
  v_exp_f32 v88, v88
  v_exp_f32 v89, v89
  v_exp_f32 v90, v90
  v_exp_f32 v91, v91
  v_exp_f32 v92, v92
  v_exp_f32 v93, v93
  v_mul_f32 v85, v85, v112
  v_mul_f32 v76, v76, v112
  v_mul_f32 v77, v77, v112
  v_mul_f32 v78, v78, v112
  v_mul_f32 v79, v79, v112
  v_mul_f32 v80, v80, v112
  v_mul_f32 v81, v81, v112
  v_mul_f32 v82, v82, v112
  v_mul_f32 v83, v83, v112
  v_cvt_pk_bf16_f32 v94, v86, 0
  v_cvt_pk_bf16_f32 v95, v87, 0
  v_cvt_pk_bf16_f32 v96, v88, 0
  v_cvt_pk_bf16_f32 v97, v89, 0
  v_cvt_pk_bf16_f32 v98, v90, 0
  v_cvt_pk_bf16_f32 v99, v91, 0
  v_cvt_pk_bf16_f32 v100, v92, 0
  v_cvt_pk_bf16_f32 v101, v93, 0
  v_add_f32 v85, v85, v86
  v_add_f32 v85, v85, v87
  v_add_f32 v85, v85, v88
  v_add_f32 v85, v85, v89
  v_add_f32 v85, v85, v90
  v_add_f32 v85, v85, v91
  v_add_f32 v85, v85, v92
  v_add_f32 v85, v85, v93
  v_lshlrev_b32 v102, 16, v94
  v_lshlrev_b32 v103, 16, v95
  v_lshlrev_b32 v104, 16, v96
  v_lshlrev_b32 v105, 16, v97
  v_lshlrev_b32 v106, 16, v98
  v_lshlrev_b32 v107, 16, v99
  v_lshlrev_b32 v108, 16, v100
  v_lshlrev_b32 v109, 16, v101
  s_waitcnt vmcnt(0)
  v_dot2_f32_bf16 v76, v40, v94, v76
  v_dot2_f32_bf16 v77, v40, v102, v77
  v_dot2_f32_bf16 v78, v41, v94, v78
  v_dot2_f32_bf16 v79, v41, v102, v79
  v_dot2_f32_bf16 v80, v42, v94, v80
  v_dot2_f32_bf16 v81, v42, v102, v81
  v_dot2_f32_bf16 v82, v43, v94, v82
  v_dot2_f32_bf16 v83, v43, v102, v83
  v_dot2_f32_bf16 v76, v44, v95, v76
  v_dot2_f32_bf16 v77, v44, v103, v77
  v_dot2_f32_bf16 v78, v45, v95, v78
  v_dot2_f32_bf16 v79, v45, v103, v79
  v_dot2_f32_bf16 v80, v46, v95, v80
  v_dot2_f32_bf16 v81, v46, v103, v81
  v_dot2_f32_bf16 v82, v47, v95, v82
  v_dot2_f32_bf16 v83, v47, v103, v83
  v_dot2_f32_bf16 v76, v48, v96, v76
  v_dot2_f32_bf16 v77, v48, v104, v77
  v_dot2_f32_bf16 v78, v49, v96, v78
  v_dot2_f32_bf16 v79, v49, v104, v79
  v_dot2_f32_bf16 v80, v50, v96, v80
  v_dot2_f32_bf16 v81, v50, v104, v81
  v_dot2_f32_bf16 v82, v51, v96, v82
  v_dot2_f32_bf16 v83, v51, v104, v83
  v_dot2_f32_bf16 v76, v52, v97, v76
  v_dot2_f32_bf16 v77, v52, v105, v77
  v_dot2_f32_bf16 v78, v53, v97, v78
  v_dot2_f32_bf16 v79, v53, v105, v79
  v_dot2_f32_bf16 v80, v54, v97, v80
  v_dot2_f32_bf16 v81, v54, v105, v81
  v_dot2_f32_bf16 v82, v55, v97, v82
  v_dot2_f32_bf16 v83, v55, v105, v83
  v_dot2_f32_bf16 v76, v56, v98, v76
  v_dot2_f32_bf16 v77, v56, v106, v77
  v_dot2_f32_bf16 v78, v57, v98, v78
  v_dot2_f32_bf16 v79, v57, v106, v79
  v_dot2_f32_bf16 v80, v58, v98, v80
  v_dot2_f32_bf16 v81, v58, v106, v81
  v_dot2_f32_bf16 v82, v59, v98, v82
  v_dot2_f32_bf16 v83, v59, v106, v83
  v_dot2_f32_bf16 v76, v60, v99, v76
  v_dot2_f32_bf16 v77, v60, v107, v77
  v_dot2_f32_bf16 v78, v61, v99, v78
  v_dot2_f32_bf16 v79, v61, v107, v79
  v_dot2_f32_bf16 v80, v62, v99, v80
  v_dot2_f32_bf16 v81, v62, v107, v81
  v_dot2_f32_bf16 v82, v63, v99, v82
  v_dot2_f32_bf16 v83, v63, v107, v83
  v_dot2_f32_bf16 v76, v64, v100, v76
  v_dot2_f32_bf16 v77, v64, v108, v77
  v_dot2_f32_bf16 v78, v65, v100, v78
  v_dot2_f32_bf16 v79, v65, v108, v79
  v_dot2_f32_bf16 v80, v66, v100, v80
  v_dot2_f32_bf16 v81, v66, v108, v81
  v_dot2_f32_bf16 v82, v67, v100, v82
  v_dot2_f32_bf16 v83, v67, v108, v83
  v_dot2_f32_bf16 v76, v68, v101, v76
  v_dot2_f32_bf16 v77, v68, v109, v77
  v_dot2_f32_bf16 v78, v69, v101, v78
  v_dot2_f32_bf16 v79, v69, v109, v79
  v_dot2_f32_bf16 v80, v70, v101, v80
  v_dot2_f32_bf16 v81, v70, v109, v81
  v_dot2_f32_bf16 v82, v71, v101, v82
  v_dot2_f32_bf16 v83, v71, v109, v83
L_dump:
  s_nop 3
  v_mov_b32 v110, v84
  v_mov_b32 v111, v84
  s_nop 1
  v_permlane16_swap_b32 v110, v111
  s_nop 1
  v_max_f32 v110, v110, v111
  v_mov_b32 v111, v110
  s_nop 1
  v_permlane32_swap_b32 v110, v111
  s_nop 1
  v_max_f32 v110, v110, v111
  v_sub_f32 v111, v84, v110
  v_mul_f32 v111, s50, v111
  v_exp_f32 v111, v111
  s_nop 1
  v_mul_f32 v76, v76, v111
  v_mul_f32 v77, v77, v111
  v_mul_f32 v78, v78, v111
  v_mul_f32 v79, v79, v111
  v_mul_f32 v80, v80, v111
  v_mul_f32 v81, v81, v111
  v_mul_f32 v82, v82, v111
  v_mul_f32 v83, v83, v111
  v_mul_f32 v85, v85, v111
  v_mov_b32 v84, v110
  s_nop 1
  v_permlane32_swap_b32 v76, v80
  v_permlane32_swap_b32 v77, v81
  v_permlane32_swap_b32 v78, v82
  v_permlane32_swap_b32 v79, v83
  v_mov_b32 v111, v85
  s_nop 1
  v_permlane32_swap_b32 v85, v111
  v_add_f32 v76, v76, v80
  v_add_f32 v77, v77, v81
  v_add_f32 v78, v78, v82
  v_add_f32 v79, v79, v83
  v_add_f32 v85, v85, v111
  s_nop 1
  v_permlane16_swap_b32 v76, v78
  v_permlane16_swap_b32 v77, v79
  v_mov_b32 v111, v85
  s_nop 1
  v_permlane16_swap_b32 v85, v111
  v_add_f32 v76, v76, v78
  v_add_f32 v77, v77, v79
  v_add_f32 v85, v85, v111
  v_lshlrev_b32 v117, 5, v4
  v_lshl_add_u32 v117, v5, 3, v117
  s_lshl_b32 s40, s36, 9
  s_lshl_b32 s41, s39, 11
  s_add_u32 s40, s40, s41
  v_add_u32 v117, s40, v117
  ds_write_b64 v117, v[76:77] offset:13312
  s_lshl_b32 s40, s36, 3
  s_lshl_b32 s41, s39, 5
  s_add_u32 s40, s40, s41
  v_mov_b32 v117, s40
  ds_write_b64 v117, v[84:85] offset:17408
  s_waitcnt lgkmcnt(0)
  v_mov_b32 v117, 21568
  v_mov_b32 v111, 1
  s_mov_b64 exec, 1
  ds_add_u32 v117, v111
  s_mov_b64 exec, -1
  s_cmp_eq_u32 s39, 0
  s_mov_b32 s39, 1
  s_cbranch_scc1 L_phase2
  s_endpgm
L_helper:
  s_setprio 3
  s_sub_u32 s63, s36, 4
  v_subrev_u32 v1, 256, v0
  v_and_b32 v8, 1, v4
  v_mov_b32 v9, 0xffff
  v_lshlrev_b32 v8, 4, v8
  v_lshlrev_b32 v9, v8, v9
  v_bfe_u32 v10, v4, 1, 2
  v_cmp_eq_u32 vcc, 0, v10
  s_nop 1
  v_cndmask_b32 v48, 0, v9, vcc
  v_cmp_eq_u32 vcc, 1, v10
  s_nop 1
  v_cndmask_b32 v49, 0, v9, vcc
  v_cmp_eq_u32 vcc, 2, v10
  s_nop 1
  v_cndmask_b32 v50, 0, v9, vcc
  v_cmp_eq_u32 vcc, 3, v10
  s_nop 1
  v_cndmask_b32 v51, 0, v9, vcc
  v_mov_b32 v8, 21568
  v_mov_b32 v12, 0
  v_mov_b32 v13, 0
  v_mov_b32 v14, 0
  v_mov_b32 v15, 0
  ds_write_b128 v8, v[12:15]
  ds_write_b128 v8, v[12:15] offset:16
  s_mov_b32 s54, 0
  s_and_b32 s40, s37, 7
  s_cmp_eq_u32 s40, s38
  s_cselect_b32 s74, 1, 0
  s_cmp_ge_u32 s37, 28
  s_cselect_b32 s74, 0, s74
  s_mov_b32 s72, 8192
  s_lshl_b32 s73, s52, 8
  s_waitcnt lgkmcnt(0)
  s_mov_b32 s70, s10
  s_mov_b32 s71, s11
  s_lshl_b32 s41, s63, 10
  v_lshlrev_b32 v2, 3, v5
  v_lshrrev_b32 v8, 3, v4
  v_lshl_add_u32 v2, v8, 2, v2
  v_add_u32 v2, s41, v2
  s_min_u32 s43, s37, 27
  s_cmp_ge_u32 s43, 14
  s_cselect_b32 s78, s18, s16
  s_cselect_b32 s79, s19, s17
  s_cselect_b32 s40, 14, 0
  s_sub_u32 s40, s43, s40
  s_lshl_b32 s43, s40, 8
  s_lshl_b32 s40, s38, 6
  s_lshl_b32 s41, s63, 4
  s_add_u32 s75, s40, s41
  v_add_u32 v10, s75, v5
  v_mul_u32_u24 v10, 3584, v10
  v_lshl_add_u32 v10, v4, 4, v10
  v_add_u32 v10, s43, v10
  global_load_dwordx4 v[192:195], v10, s[78:79] nt
  v_add_u32 v10, 14336, v10
  global_load_dwordx4 v[196:199], v10, s[78:79] nt
  v_add_u32 v10, 14336, v10
  global_load_dwordx4 v[200:203], v10, s[78:79] nt
  v_add_u32 v10, 14336, v10
  global_load_dwordx4 v[204:207], v10, s[78:79] nt
L_gemv:
  s_lshl_b32 s40, s63, 7
  v_add_u32 v8, s40, v5
  v_mul_lo_u32 v8, v8, s72
  v_lshl_add_u32 v8, v4, 4, v8
  v_add_u32 v8, s73, v8
  s_lshl_b32 s42, s72, 2
  global_load_dwordx4 v[64:67], v8, s[70:71] nt
  v_add_u32 v8, s42, v8
  global_load_dwordx4 v[68:71], v8, s[70:71] nt
  v_add_u32 v8, s42, v8
  global_load_dwordx4 v[72:75], v8, s[70:71] nt
  v_add_u32 v8, s42, v8
  global_load_dwordx4 v[76:79], v8, s[70:71] nt
  v_add_u32 v8, s42, v8
  global_load_dwordx4 v[80:83], v8, s[70:71] nt
  v_add_u32 v8, s42, v8
  global_load_dwordx4 v[84:87], v8, s[70:71] nt
  v_add_u32 v8, s42, v8
  global_load_dwordx4 v[88:91], v8, s[70:71] nt
  v_add_u32 v8, s42, v8
  global_load_dwordx4 v[92:95], v8, s[70:71] nt
  v_add_u32 v8, s42, v8
  global_load_dwordx4 v[96:99], v8, s[70:71] nt
  v_add_u32 v8, s42, v8
  global_load_dwordx4 v[100:103], v8, s[70:71] nt
  v_add_u32 v8, s42, v8
  global_load_dwordx4 v[104:107], v8, s[70:71] nt
  v_add_u32 v8, s42, v8
  global_load_dwordx4 v[108:111], v8, s[70:71] nt
  v_add_u32 v8, s42, v8
  global_load_dwordx4 v[112:115], v8, s[70:71] nt
  v_add_u32 v8, s42, v8
  global_load_dwordx4 v[116:119], v8, s[70:71] nt
  v_add_u32 v8, s42, v8
  global_load_dwordx4 v[120:123], v8, s[70:71] nt
  v_add_u32 v8, s42, v8
  global_load_dwordx4 v[124:127], v8, s[70:71] nt
  v_add_u32 v8, s42, v8
  global_load_dwordx4 v[128:131], v8, s[70:71] nt
  v_add_u32 v8, s42, v8
  global_load_dwordx4 v[132:135], v8, s[70:71] nt
  v_add_u32 v8, s42, v8
  global_load_dwordx4 v[136:139], v8, s[70:71] nt
  v_add_u32 v8, s42, v8
  global_load_dwordx4 v[140:143], v8, s[70:71] nt
  v_add_u32 v8, s42, v8
  global_load_dwordx4 v[144:147], v8, s[70:71] nt
  v_add_u32 v8, s42, v8
  global_load_dwordx4 v[148:151], v8, s[70:71] nt
  v_add_u32 v8, s42, v8
  global_load_dwordx4 v[152:155], v8, s[70:71] nt
  v_add_u32 v8, s42, v8
  global_load_dwordx4 v[156:159], v8, s[70:71] nt
  v_add_u32 v8, s42, v8
  global_load_dwordx4 v[160:163], v8, s[70:71] nt
  v_add_u32 v8, s42, v8
  global_load_dwordx4 v[164:167], v8, s[70:71] nt
  v_add_u32 v8, s42, v8
  global_load_dwordx4 v[168:171], v8, s[70:71] nt
  v_add_u32 v8, s42, v8
  global_load_dwordx4 v[172:175], v8, s[70:71] nt
  v_add_u32 v8, s42, v8
  global_load_dwordx4 v[176:179], v8, s[70:71] nt
  v_add_u32 v8, s42, v8
  global_load_dwordx4 v[180:183], v8, s[70:71] nt
  v_add_u32 v8, s42, v8
  global_load_dwordx4 v[184:187], v8, s[70:71] nt
  v_add_u32 v8, s42, v8
  global_load_dwordx4 v[188:191], v8, s[70:71] nt
  s_barrier
  ds_read_b32 v16, v2 offset:0
  ds_read_b32 v17, v2 offset:32
  ds_read_b32 v18, v2 offset:64
  ds_read_b32 v19, v2 offset:96
  ds_read_b32 v20, v2 offset:128
  ds_read_b32 v21, v2 offset:160
  ds_read_b32 v22, v2 offset:192
  ds_read_b32 v23, v2 offset:224
  ds_read_b32 v24, v2 offset:256
  ds_read_b32 v25, v2 offset:288
  ds_read_b32 v26, v2 offset:320
  ds_read_b32 v27, v2 offset:352
  ds_read_b32 v28, v2 offset:384
  ds_read_b32 v29, v2 offset:416
  ds_read_b32 v30, v2 offset:448
  ds_read_b32 v31, v2 offset:480
  ds_read_b32 v32, v2 offset:512
  ds_read_b32 v33, v2 offset:544
  ds_read_b32 v34, v2 offset:576
  ds_read_b32 v35, v2 offset:608
  ds_read_b32 v36, v2 offset:640
  ds_read_b32 v37, v2 offset:672
  ds_read_b32 v38, v2 offset:704
  ds_read_b32 v39, v2 offset:736
  ds_read_b32 v40, v2 offset:768
  ds_read_b32 v41, v2 offset:800
  ds_read_b32 v42, v2 offset:832
  ds_read_b32 v43, v2 offset:864
  ds_read_b32 v44, v2 offset:896
  ds_read_b32 v45, v2 offset:928
  ds_read_b32 v46, v2 offset:960
  ds_read_b32 v47, v2 offset:992
  v_mov_b32 v60, 0
  v_mov_b32 v61, 0
  v_mov_b32 v62, 0
  v_mov_b32 v63, 0
  s_waitcnt lgkmcnt(0)
  v_and_b32 v52, v16, v48
  v_and_b32 v53, v16, v49
  v_and_b32 v54, v16, v50
  v_and_b32 v55, v16, v51
  v_and_b32 v56, v17, v48
  v_and_b32 v57, v17, v49
  v_and_b32 v58, v17, v50
  v_and_b32 v59, v17, v51
  s_waitcnt vmcnt(31)
  v_mfma_f32_16x16x32_bf16 v[60:63], v[64:67], v[52:55], v[60:63]
  v_and_b32 v52, v18, v48
  v_and_b32 v53, v18, v49
  v_and_b32 v54, v18, v50
  v_and_b32 v55, v18, v51
  s_waitcnt vmcnt(30)
  v_mfma_f32_16x16x32_bf16 v[60:63], v[68:71], v[56:59], v[60:63]
  v_and_b32 v56, v19, v48
  v_and_b32 v57, v19, v49
  v_and_b32 v58, v19, v50
  v_and_b32 v59, v19, v51
  s_waitcnt vmcnt(29)
  v_mfma_f32_16x16x32_bf16 v[60:63], v[72:75], v[52:55], v[60:63]
  v_and_b32 v52, v20, v48
  v_and_b32 v53, v20, v49
  v_and_b32 v54, v20, v50
  v_and_b32 v55, v20, v51
  s_waitcnt vmcnt(28)
  v_mfma_f32_16x16x32_bf16 v[60:63], v[76:79], v[56:59], v[60:63]
  v_and_b32 v56, v21, v48
  v_and_b32 v57, v21, v49
  v_and_b32 v58, v21, v50
  v_and_b32 v59, v21, v51
  s_waitcnt vmcnt(27)
  v_mfma_f32_16x16x32_bf16 v[60:63], v[80:83], v[52:55], v[60:63]
  v_and_b32 v52, v22, v48
  v_and_b32 v53, v22, v49
  v_and_b32 v54, v22, v50
  v_and_b32 v55, v22, v51
  s_waitcnt vmcnt(26)
  v_mfma_f32_16x16x32_bf16 v[60:63], v[84:87], v[56:59], v[60:63]
  v_and_b32 v56, v23, v48
  v_and_b32 v57, v23, v49
  v_and_b32 v58, v23, v50
  v_and_b32 v59, v23, v51
  s_waitcnt vmcnt(25)
  v_mfma_f32_16x16x32_bf16 v[60:63], v[88:91], v[52:55], v[60:63]
  v_and_b32 v52, v24, v48
  v_and_b32 v53, v24, v49
  v_and_b32 v54, v24, v50
  v_and_b32 v55, v24, v51
  s_waitcnt vmcnt(24)
  v_mfma_f32_16x16x32_bf16 v[60:63], v[92:95], v[56:59], v[60:63]
  v_and_b32 v56, v25, v48
  v_and_b32 v57, v25, v49
  v_and_b32 v58, v25, v50
  v_and_b32 v59, v25, v51
  s_waitcnt vmcnt(23)
  v_mfma_f32_16x16x32_bf16 v[60:63], v[96:99], v[52:55], v[60:63]
  v_and_b32 v52, v26, v48
  v_and_b32 v53, v26, v49
  v_and_b32 v54, v26, v50
  v_and_b32 v55, v26, v51
  s_waitcnt vmcnt(22)
  v_mfma_f32_16x16x32_bf16 v[60:63], v[100:103], v[56:59], v[60:63]
  v_and_b32 v56, v27, v48
  v_and_b32 v57, v27, v49
  v_and_b32 v58, v27, v50
  v_and_b32 v59, v27, v51
  s_waitcnt vmcnt(21)
  v_mfma_f32_16x16x32_bf16 v[60:63], v[104:107], v[52:55], v[60:63]
  v_and_b32 v52, v28, v48
  v_and_b32 v53, v28, v49
  v_and_b32 v54, v28, v50
  v_and_b32 v55, v28, v51
  s_waitcnt vmcnt(20)
  v_mfma_f32_16x16x32_bf16 v[60:63], v[108:111], v[56:59], v[60:63]
  v_and_b32 v56, v29, v48
  v_and_b32 v57, v29, v49
  v_and_b32 v58, v29, v50
  v_and_b32 v59, v29, v51
  s_waitcnt vmcnt(19)
  v_mfma_f32_16x16x32_bf16 v[60:63], v[112:115], v[52:55], v[60:63]
  v_and_b32 v52, v30, v48
  v_and_b32 v53, v30, v49
  v_and_b32 v54, v30, v50
  v_and_b32 v55, v30, v51
  s_waitcnt vmcnt(18)
  v_mfma_f32_16x16x32_bf16 v[60:63], v[116:119], v[56:59], v[60:63]
  v_and_b32 v56, v31, v48
  v_and_b32 v57, v31, v49
  v_and_b32 v58, v31, v50
  v_and_b32 v59, v31, v51
  s_waitcnt vmcnt(17)
  v_mfma_f32_16x16x32_bf16 v[60:63], v[120:123], v[52:55], v[60:63]
  v_and_b32 v52, v32, v48
  v_and_b32 v53, v32, v49
  v_and_b32 v54, v32, v50
  v_and_b32 v55, v32, v51
  s_waitcnt vmcnt(16)
  v_mfma_f32_16x16x32_bf16 v[60:63], v[124:127], v[56:59], v[60:63]
  v_and_b32 v56, v33, v48
  v_and_b32 v57, v33, v49
  v_and_b32 v58, v33, v50
  v_and_b32 v59, v33, v51
  s_waitcnt vmcnt(15)
  v_mfma_f32_16x16x32_bf16 v[60:63], v[128:131], v[52:55], v[60:63]
  v_and_b32 v52, v34, v48
  v_and_b32 v53, v34, v49
  v_and_b32 v54, v34, v50
  v_and_b32 v55, v34, v51
  s_waitcnt vmcnt(14)
  v_mfma_f32_16x16x32_bf16 v[60:63], v[132:135], v[56:59], v[60:63]
  v_and_b32 v56, v35, v48
  v_and_b32 v57, v35, v49
  v_and_b32 v58, v35, v50
  v_and_b32 v59, v35, v51
  s_waitcnt vmcnt(13)
  v_mfma_f32_16x16x32_bf16 v[60:63], v[136:139], v[52:55], v[60:63]
  v_and_b32 v52, v36, v48
  v_and_b32 v53, v36, v49
  v_and_b32 v54, v36, v50
  v_and_b32 v55, v36, v51
  s_waitcnt vmcnt(12)
  v_mfma_f32_16x16x32_bf16 v[60:63], v[140:143], v[56:59], v[60:63]
  v_and_b32 v56, v37, v48
  v_and_b32 v57, v37, v49
  v_and_b32 v58, v37, v50
  v_and_b32 v59, v37, v51
  s_waitcnt vmcnt(11)
  v_mfma_f32_16x16x32_bf16 v[60:63], v[144:147], v[52:55], v[60:63]
  v_and_b32 v52, v38, v48
  v_and_b32 v53, v38, v49
  v_and_b32 v54, v38, v50
  v_and_b32 v55, v38, v51
  s_waitcnt vmcnt(10)
  v_mfma_f32_16x16x32_bf16 v[60:63], v[148:151], v[56:59], v[60:63]
  v_and_b32 v56, v39, v48
  v_and_b32 v57, v39, v49
  v_and_b32 v58, v39, v50
  v_and_b32 v59, v39, v51
  s_waitcnt vmcnt(9)
  v_mfma_f32_16x16x32_bf16 v[60:63], v[152:155], v[52:55], v[60:63]
  v_and_b32 v52, v40, v48
  v_and_b32 v53, v40, v49
  v_and_b32 v54, v40, v50
  v_and_b32 v55, v40, v51
  s_waitcnt vmcnt(8)
  v_mfma_f32_16x16x32_bf16 v[60:63], v[156:159], v[56:59], v[60:63]
  v_and_b32 v56, v41, v48
  v_and_b32 v57, v41, v49
  v_and_b32 v58, v41, v50
  v_and_b32 v59, v41, v51
  s_waitcnt vmcnt(7)
  v_mfma_f32_16x16x32_bf16 v[60:63], v[160:163], v[52:55], v[60:63]
  v_and_b32 v52, v42, v48
  v_and_b32 v53, v42, v49
  v_and_b32 v54, v42, v50
  v_and_b32 v55, v42, v51
  s_waitcnt vmcnt(6)
  v_mfma_f32_16x16x32_bf16 v[60:63], v[164:167], v[56:59], v[60:63]
  v_and_b32 v56, v43, v48
  v_and_b32 v57, v43, v49
  v_and_b32 v58, v43, v50
  v_and_b32 v59, v43, v51
  s_waitcnt vmcnt(5)
  v_mfma_f32_16x16x32_bf16 v[60:63], v[168:171], v[52:55], v[60:63]
  v_and_b32 v52, v44, v48
  v_and_b32 v53, v44, v49
  v_and_b32 v54, v44, v50
  v_and_b32 v55, v44, v51
  s_waitcnt vmcnt(4)
  v_mfma_f32_16x16x32_bf16 v[60:63], v[172:175], v[56:59], v[60:63]
  v_and_b32 v56, v45, v48
  v_and_b32 v57, v45, v49
  v_and_b32 v58, v45, v50
  v_and_b32 v59, v45, v51
  s_waitcnt vmcnt(3)
  v_mfma_f32_16x16x32_bf16 v[60:63], v[176:179], v[52:55], v[60:63]
  v_and_b32 v52, v46, v48
  v_and_b32 v53, v46, v49
  v_and_b32 v54, v46, v50
  v_and_b32 v55, v46, v51
  s_waitcnt vmcnt(2)
  v_mfma_f32_16x16x32_bf16 v[60:63], v[180:183], v[56:59], v[60:63]
  v_and_b32 v56, v47, v48
  v_and_b32 v57, v47, v49
  v_and_b32 v58, v47, v50
  v_and_b32 v59, v47, v51
  s_waitcnt vmcnt(1)
  v_mfma_f32_16x16x32_bf16 v[60:63], v[184:187], v[52:55], v[60:63]
  s_nop 1
  s_waitcnt vmcnt(0)
  v_mfma_f32_16x16x32_bf16 v[60:63], v[188:191], v[56:59], v[60:63]
  v_lshrrev_b32 v8, 3, v4
  v_lshlrev_b32 v8, 9, v8
  v_lshl_add_u32 v8, v5, 7, v8
  v_and_b32 v9, 7, v4
  v_lshl_add_u32 v8, v9, 2, v8
  s_lshl_b32 s41, s63, 10
  v_add_u32 v8, s41, v8
  s_nop 7
  ds_write_b32 v8, v60 offset:4096
  ds_write_b32 v8, v61 offset:4128
  ds_write_b32 v8, v62 offset:4160
  ds_write_b32 v8, v63 offset:4192
  s_waitcnt lgkmcnt(0)
  s_barrier
  s_cmp_ge_u32 s2, 224
  s_cbranch_scc1 L_gemv_done
  s_lshl_b32 s40, s75, 3
  v_lshlrev_b32 v9, 3, v5
  v_lshrrev_b32 v10, 3, v4
  v_lshl_add_u32 v9, v10, 2, v9
  v_add_u32 v9, s40, v9
  ds_read_b32 v16, v9 offset:0
  ds_read_b32 v17, v9 offset:32
  ds_read_b32 v18, v9 offset:64
  ds_read_b32 v19, v9 offset:96
  v_mov_b32 v60, 0
  v_mov_b32 v61, 0
  v_mov_b32 v62, 0
  v_mov_b32 v63, 0
  s_waitcnt lgkmcnt(0)
  v_and_b32 v20, v16, v48
  v_and_b32 v21, v16, v49
  v_and_b32 v22, v16, v50
  v_and_b32 v23, v16, v51
  v_and_b32 v24, v17, v48
  v_and_b32 v25, v17, v49
  v_and_b32 v26, v17, v50
  v_and_b32 v27, v17, v51
  v_and_b32 v28, v18, v48
  v_and_b32 v29, v18, v49
  v_and_b32 v30, v18, v50
  v_and_b32 v31, v18, v51
  v_and_b32 v32, v19, v48
  v_and_b32 v33, v19, v49
  v_and_b32 v34, v19, v50
  v_and_b32 v35, v19, v51
  s_waitcnt vmcnt(0)
  v_mfma_f32_16x16x32_bf16 v[60:63], v[192:195], v[20:23], v[60:63]
  v_mfma_f32_16x16x32_bf16 v[60:63], v[196:199], v[24:27], v[60:63]
  v_mfma_f32_16x16x32_bf16 v[60:63], v[200:203], v[28:31], v[60:63]
  v_mfma_f32_16x16x32_bf16 v[60:63], v[204:207], v[32:35], v[60:63]
  v_lshrrev_b32 v8, 3, v4
  v_lshlrev_b32 v8, 9, v8
  v_lshl_add_u32 v8, v5, 7, v8
  v_and_b32 v9, 7, v4
  v_lshl_add_u32 v8, v9, 2, v8
  s_lshl_b32 s41, s63, 10
  v_add_u32 v8, s41, v8
  s_nop 7
  ds_write_b32 v8, v60 offset:8192
  ds_write_b32 v8, v61 offset:8224
  ds_write_b32 v8, v62 offset:8256
  ds_write_b32 v8, v63 offset:8288
  s_waitcnt lgkmcnt(0)
L_gemv_done:
  v_mov_b32 v88, 0
  v_mov_b32 v89, 0
  v_mov_b32 v90, 0
  v_mov_b32 v91, 0
  s_cmp_eq_u32 s63, 1
  s_cbranch_scc0 L_nclr1
  s_lshl_b32 s40, s52, 3
  s_add_u32 s40, s40, s53
  s_lshl_b32 s40, s40, 12
  s_add_u32 s40, s40, 0x20000
  v_add_u32 v32, s40, v6
  global_store_dwordx4 v32, v[88:91], s[26:27] offset:0 sc0 sc1
  global_store_dwordx4 v32, v[88:91], s[26:27] offset:1024 sc0 sc1
  global_store_dwordx4 v32, v[88:91], s[26:27] offset:2048 sc0 sc1
  s_lshl_b32 s40, s2, 12
  s_add_u32 s40, s40, 0x120000
  v_add_u32 v33, s40, v6
  global_store_dwordx4 v33, v[88:91], s[26:27] offset:0 sc0 sc1
  global_store_dwordx4 v33, v[88:91], s[26:27] offset:1024 sc0 sc1
  global_store_dwordx4 v33, v[88:91], s[26:27] offset:2048 sc0 sc1
L_nclr1:
  s_cmp_eq_u32 s63, 2
  s_cbranch_scc0 L_nclr2
  s_lshl_b32 s40, s38, 5
  s_add_u32 s40, s40, s37
  s_lshl_b32 s40, s40, 10
  s_add_u32 s40, s40, 0x300000
  v_add_u32 v32, s40, v6
  global_store_dwordx4 v32, v[88:91], s[26:27] sc0 sc1
L_nclr2:
  s_waitcnt vmcnt(0)
  v_mov_b32 v36, 21572
  v_mov_b32 v37, 1
  s_mov_b64 exec, 1
  ds_add_u32 v36, v37
  s_mov_b64 exec, -1
  v_mov_b32 v132, 0xff800000
  v_mov_b32 v133, 0
  v_mov_b32 v134, 0
  v_mov_b32 v135, 0
  s_cmp_eq_u32 s63, 0
  s_cbranch_scc0 L_h_rounds
  v_mov_b32 v44, 21572
  s_mov_b32 s62, 1048576
L_pollf:
  ds_read_b32 v45, v44
  s_waitcnt lgkmcnt(0)
  v_readfirstlane_b32 s41, v45
  s_sub_u32 s62, s62, 1
  s_cmp_eq_u32 s62, 0
  s_cbranch_scc1 L_pollf_done
  s_cmp_ge_u32 s41, 4
  s_cbranch_scc1 L_pollf_done
  s_sleep 1
  s_branch L_pollf
L_pollf_done:
  v_lshrrev_b32 v32, 5, v3
  v_and_b32 v34, 31, v3
  v_lshlrev_b32 v34, 4, v34
  s_cmp_lg_u32 s53, 0
  s_cbranch_scc1 L_noq
  ds_read_b128 v[64:67], v6 offset:4096
  ds_read_b128 v[68:71], v6 offset:5120
  ds_read_b128 v[72:75], v6 offset:6144
  ds_read_b128 v[76:79], v6 offset:7168
  s_waitcnt lgkmcnt(0)
  v_add_f32 v64, v64, v68
  v_add_f32 v72, v72, v76
  v_add_f32 v80, v64, v72
  v_cvt_pk_bf16_f32 v80, v80, v80
  v_and_b32 v80, s64, v80
  v_add_f32 v65, v65, v69
  v_add_f32 v73, v73, v77
  v_add_f32 v81, v65, v73
  v_cvt_pk_bf16_f32 v81, v81, v81
  v_and_b32 v81, s64, v81
  v_add_f32 v66, v66, v70
  v_add_f32 v74, v74, v78
  v_add_f32 v82, v66, v74
  v_cvt_pk_bf16_f32 v82, v82, v82
  v_and_b32 v82, s64, v82
  v_add_f32 v67, v67, v71
  v_add_f32 v75, v75, v79
  v_add_f32 v83, v67, v75
  v_cvt_pk_bf16_f32 v83, v83, v83
  v_and_b32 v83, s64, v83
  v_lshl_add_u32 v33, v32, 14, v34
  s_lshl_b32 s40, s52, 9
  s_add_u32 s40, s40, 0x0
  v_add_u32 v33, s40, v33
  global_store_dwordx4 v33, v[80:83], s[26:27] sc0 sc1
  s_lshl_b32 s40, s52, 8
  s_add_u32 s40, s40, 0x10000
  v_lshlrev_b32 v42, 13, v3
  v_add_u32 v42, s40, v42
  v_mov_b32 v88, 0
  s_mov_b64 exec, 3
  global_store_dword v42, v88, s[26:27] sc0 sc1
  s_mov_b64 exec, -1
L_noq:
  s_cmp_ge_u32 s2, 224
  s_cbranch_scc1 L_nog
  ds_read_b128 v[64:67], v6 offset:8192
  ds_read_b128 v[68:71], v6 offset:9216
  ds_read_b128 v[72:75], v6 offset:10240
  ds_read_b128 v[76:79], v6 offset:11264
  s_waitcnt lgkmcnt(0)
  v_add_f32 v64, v64, v68
  v_add_f32 v72, v72, v76
  v_add_f32 v84, v64, v72
  v_add_f32 v65, v65, v69
  v_add_f32 v73, v73, v77
  v_add_f32 v85, v65, v73
  v_add_f32 v66, v66, v70
  v_add_f32 v74, v74, v78
  v_add_f32 v86, v66, v74
  v_add_f32 v67, v67, v71
  v_add_f32 v75, v75, v79
  v_add_f32 v87, v67, v75
  s_lshl_b32 s40, s2, 10
  s_add_u32 s40, s40, 0x340000
  v_add_u32 v33, s40, v6
  global_store_dwordx4 v33, v[84:87], s[26:27] sc0 sc1
L_nog:
  s_waitcnt vmcnt(0)
  s_lshl_b32 s40, s37, 2
  v_mov_b32 v42, s40
  v_mov_b32 v43, 1
  s_mov_b64 exec, 1
  global_atomic_add v42, v43, s[24:25] sc1
  s_mov_b64 exec, -1
  v_mov_b32 v44, 21580
  s_mov_b32 s62, 1048576
L_pprog:
  ds_read_b32 v45, v44
  s_waitcnt lgkmcnt(0)
  v_readfirstlane_b32 s41, v45
  s_sub_u32 s62, s62, 1
  s_cmp_eq_u32 s62, 0
  s_cbranch_scc1 L_pprog_done
  s_cmp_ge_u32 s41, 1
  s_cbranch_scc1 L_pprog_done
  s_sleep 32
  s_branch L_pprog
L_pprog_done:
  v_and_b32 v42, 31, v3
  v_lshlrev_b32 v42, 2, v42
  s_mov_b32 s62, 1048576
L_pollall:
  global_load_dword v43, v42, s[24:25] sc0 sc1
  s_waitcnt vmcnt(0)
  v_cmp_gt_u32 vcc, 8, v43
  s_sub_u32 s62, s62, 1
  s_cmp_eq_u32 s62, 0
  s_cbranch_scc1 L_pollall_done
  s_cbranch_vccz L_pollall_done
  s_sleep 64
  s_branch L_pollall
L_pollall_done:
  v_lshl_add_u32 v33, v32, 14, v34
  s_lshl_b32 s40, s37, 9
  s_add_u32 s40, s40, 0x0
  v_add_u32 v33, s40, v33
  global_load_dwordx4 v[36:39], v33, s[26:27] sc0 sc1
  v_lshlrev_b32 v35, 8, v32
  v_lshrrev_b32 v40, 1, v34
  v_add_u32 v35, v35, v40
  v_min_u32 v42, 55, v3
  s_mul_i32 s40, s37, 56
  v_add_u32 v42, s40, v42
  v_lshrrev_b32 v43, 7, v42
  v_and_b32 v42, 127, v42
  v_lshlrev_b32 v42, 2, v42
  v_lshl_add_u32 v42, v43, 13, v42
  v_add_u32 v42, 0x340000, v42
  v_add_u32 v43, 0, v42
  global_load_dword v136, v43, s[26:27] offset:0 sc0 sc1
  global_load_dword v144, v43, s[26:27] offset:512 sc0 sc1
  v_add_u32 v43, 1024, v42
  global_load_dword v137, v43, s[26:27] offset:0 sc0 sc1
  global_load_dword v145, v43, s[26:27] offset:512 sc0 sc1
  v_add_u32 v43, 2048, v42
  global_load_dword v138, v43, s[26:27] offset:0 sc0 sc1
  global_load_dword v146, v43, s[26:27] offset:512 sc0 sc1
  v_add_u32 v43, 3072, v42
  global_load_dword v139, v43, s[26:27] offset:0 sc0 sc1
  global_load_dword v147, v43, s[26:27] offset:512 sc0 sc1
  v_add_u32 v43, 4096, v42
  global_load_dword v140, v43, s[26:27] offset:0 sc0 sc1
  global_load_dword v148, v43, s[26:27] offset:512 sc0 sc1
  v_add_u32 v43, 5120, v42
  global_load_dword v141, v43, s[26:27] offset:0 sc0 sc1
  global_load_dword v149, v43, s[26:27] offset:512 sc0 sc1
  v_add_u32 v43, 6144, v42
  global_load_dword v142, v43, s[26:27] offset:0 sc0 sc1
  global_load_dword v150, v43, s[26:27] offset:512 sc0 sc1
  v_add_u32 v43, 7168, v42
  global_load_dword v143, v43, s[26:27] offset:0 sc0 sc1
  global_load_dword v151, v43, s[26:27] offset:512 sc0 sc1
  v_add_u32 v43, 114688, v42
  global_load_dword v152, v43, s[26:27] offset:0 sc0 sc1
  global_load_dword v160, v43, s[26:27] offset:512 sc0 sc1
  v_add_u32 v43, 115712, v42
  global_load_dword v153, v43, s[26:27] offset:0 sc0 sc1
  global_load_dword v161, v43, s[26:27] offset:512 sc0 sc1
  v_add_u32 v43, 116736, v42
  global_load_dword v154, v43, s[26:27] offset:0 sc0 sc1
  global_load_dword v162, v43, s[26:27] offset:512 sc0 sc1
  v_add_u32 v43, 117760, v42
  global_load_dword v155, v43, s[26:27] offset:0 sc0 sc1
  global_load_dword v163, v43, s[26:27] offset:512 sc0 sc1
  v_add_u32 v43, 118784, v42
  global_load_dword v156, v43, s[26:27] offset:0 sc0 sc1
  global_load_dword v164, v43, s[26:27] offset:512 sc0 sc1
  v_add_u32 v43, 119808, v42
  global_load_dword v157, v43, s[26:27] offset:0 sc0 sc1
  global_load_dword v165, v43, s[26:27] offset:512 sc0 sc1
  v_add_u32 v43, 120832, v42
  global_load_dword v158, v43, s[26:27] offset:0 sc0 sc1
  global_load_dword v166, v43, s[26:27] offset:512 sc0 sc1
  v_add_u32 v43, 121856, v42
  global_load_dword v159, v43, s[26:27] offset:0 sc0 sc1
  global_load_dword v167, v43, s[26:27] offset:512 sc0 sc1
  s_waitcnt vmcnt(0)
  v_add_f32 v136, v136, v137
  v_add_f32 v138, v138, v139
  v_add_f32 v140, v140, v141
  v_add_f32 v142, v142, v143
  v_add_f32 v136, v136, v138
  v_add_f32 v140, v140, v142
  v_add_f32 v64, v136, v140
  v_cvt_pk_bf16_f32 v64, v64, v64
  v_and_b32 v64, s64, v64
  v_add_f32 v144, v144, v145
  v_add_f32 v146, v146, v147
  v_add_f32 v148, v148, v149
  v_add_f32 v150, v150, v151
  v_add_f32 v144, v144, v146
  v_add_f32 v148, v148, v150
  v_add_f32 v65, v144, v148
  v_cvt_pk_bf16_f32 v65, v65, v65
  v_and_b32 v65, s64, v65
  v_add_f32 v152, v152, v153
  v_add_f32 v154, v154, v155
  v_add_f32 v156, v156, v157
  v_add_f32 v158, v158, v159
  v_add_f32 v152, v152, v154
  v_add_f32 v156, v156, v158
  v_add_f32 v66, v152, v156
  v_cvt_pk_bf16_f32 v66, v66, v66
  v_and_b32 v66, s64, v66
  v_add_f32 v160, v160, v161
  v_add_f32 v162, v162, v163
  v_add_f32 v164, v164, v165
  v_add_f32 v166, v166, v167
  v_add_f32 v160, v160, v162
  v_add_f32 v164, v164, v166
  v_add_f32 v67, v160, v164
  v_cvt_pk_bf16_f32 v67, v67, v67
  v_and_b32 v67, s64, v67
  v_cvt_pk_bf16_f32 v40, v36, v37
  v_cvt_pk_bf16_f32 v41, v38, v39
  ds_write_b64 v35, v[40:41] offset:12288
  v_mul_f32 v68, 0xbfb8aa3b, v64
  v_mul_f32 v69, 0xbfb8aa3b, v65
  v_exp_f32 v68, v68
  v_exp_f32 v69, v69
  s_nop 0
  v_add_f32 v68, 1.0, v68
  v_add_f32 v69, 1.0, v69
  v_rcp_f32 v68, v68
  v_rcp_f32 v69, v69
  s_nop 0
  v_cmp_gt_u32 vcc, 56, v3
  v_mul_f32 v68, v64, v68
  v_cvt_pk_bf16_f32 v68, v68, v68
  v_and_b32 v68, s64, v68
  v_mul_f32 v68, v68, v66
  v_cvt_pk_bf16_f32 v68, v68, v68
  v_and_b32 v68, s64, v68
  v_mul_f32 v69, v65, v69
  v_cvt_pk_bf16_f32 v69, v69, v69
  v_and_b32 v69, s64, v69
  v_mul_f32 v69, v69, v67
  v_cvt_pk_bf16_f32 v69, v69, v69
  v_and_b32 v69, s64, v69
  v_cndmask_b32 v68, 0, v68, vcc
  v_cndmask_b32 v69, 0, v69, vcc
  v_lshlrev_b32 v34, 3, v3
  ds_write_b64 v34, v[68:69] offset:12800
  v_mov_b32 v36, 21576
  v_mov_b32 v37, 1
  s_waitcnt lgkmcnt(0)
  ds_write_b32 v36, v37
L_h_rounds:
  v_mov_b32 v44, 21576
  s_mov_b32 s62, 1048576
L_pg:
  ds_read_b32 v45, v44
  s_waitcnt lgkmcnt(0)
  v_readfirstlane_b32 s41, v45
  s_sub_u32 s62, s62, 1
  s_cmp_eq_u32 s62, 0
  s_cbranch_scc1 L_pg_done
  s_cmp_ge_u32 s41, 1
  s_cbranch_scc1 L_pg_done
  s_sleep 32
  s_branch L_pg
L_pg_done:
L_round:
  s_lshl_b32 s43, s39, 2
  s_add_u32 s43, s43, 4
  v_mov_b32 v44, 21568
  s_mov_b32 s62, 1048576
L_pd:
  ds_read_b32 v45, v44
  s_waitcnt lgkmcnt(0)
  v_readfirstlane_b32 s41, v45
  s_sub_u32 s62, s62, 1
  s_cmp_eq_u32 s62, 0
  s_cbranch_scc1 L_pd_done
  s_cmp_ge_u32 s41, s43
  s_cbranch_scc1 L_pd_done
  s_sleep 2
  s_branch L_pd
L_pd_done:
  s_lshl_b32 s40, s52, 3
  s_add_u32 s40, s40, s53
  s_add_u32 s41, s2, 256
  s_cmp_eq_u32 s39, 0
  s_cselect_b32 s68, s40, s41
  s_cmp_ge_u32 s63, 3
  s_cbranch_scc1 L_t3_done
  v_and_b32 v32, 1, v3
  v_mov_b32 v33, s63
  s_cmp_eq_u32 s63, 2
  s_cselect_b64 vcc, -1, 0
  v_cndmask_b32 v32, v33, v32, vcc
  s_lshl_b32 s40, s39, 5
  v_lshlrev_b32 v33, 3, v32
  v_add_u32 v33, s40, v33
  ds_read_b64 v[34:35], v33 offset:17408
  ds_read_b64 v[36:37], v33 offset:17424
  s_lshl_b32 s40, s39, 11
  v_lshlrev_b32 v38, 9, v32
  v_lshl_add_u32 v38, v3, 3, v38
  v_add_u32 v38, s40, v38
  ds_read_b64 v[40:41], v38 offset:13312
  ds_read_b64 v[42:43], v38 offset:14336
  s_waitcnt lgkmcnt(0)
  v_max_f32 v44, v34, v36
  v_sub_f32 v34, v34, v44
  v_sub_f32 v36, v36, v44
  v_mul_f32 v34, s50, v34
  v_mul_f32 v36, s50, v36
  v_exp_f32 v34, v34
  v_exp_f32 v36, v36
  s_nop 0
  v_mul_f32 v35, v35, v34
  v_fmac_f32 v35, v37, v36
  v_mul_f32 v40, v40, v34
  v_mul_f32 v41, v41, v34
  v_fmac_f32 v40, v42, v36
  v_fmac_f32 v41, v43, v36
  v_mov_b32 v97, 0x5bd1e995
  v_mov_b32 v99, 0x5bd1e995
  s_cmp_eq_u32 s63, 2
  s_cselect_b64 vcc, -1, 0
  v_cndmask_b32 v96, v40, v44, vcc
  v_cndmask_b32 v98, v41, v35, vcc
  s_lshl_b32 s40, s68, 12
  s_add_u32 s40, s40, 0x20000
  s_lshl_b32 s41, s63, 10
  s_add_u32 s40, s40, s41
  v_lshlrev_b32 v33, 4, v3
  v_add_u32 v33, s40, v33
  s_cmp_eq_u32 s63, 2
  s_cselect_b64 exec, 3, -1
  global_store_dwordx4 v33, v[96:99], s[26:27] sc0 sc1
  s_mov_b64 exec, -1
L_t3_done:
  s_cmp_eq_u32 s39, 0
  s_cbranch_scc1 L_now
  v_lshrrev_b32 v80, 3, v1
  v_and_b32 v81, 7, v1
  v_lshlrev_b32 v82, 10, v80
  v_lshl_add_u32 v82, v81, 4, v82
  s_lshl_b32 s40, s37, 17
  s_lshl_b32 s41, s38, 7
  s_add_u32 s40, s40, s41
  v_add_u32 v83, s40, v82
  global_load_dwordx4 v[192:195], v83, s[12:13] nt
  v_add_u32 v83, 0x8000, v83
  global_load_dwordx4 v[196:199], v83, s[12:13] nt
  v_add_u32 v83, 0x8000, v83
  global_load_dwordx4 v[200:203], v83, s[12:13] nt
  v_add_u32 v83, 0x8000, v83
  global_load_dwordx4 v[204:207], v83, s[12:13] nt
  s_mul_i32 s40, s37, 57344
  s_add_u32 s40, s40, s41
  v_add_u32 v83, s40, v82
  global_load_dwordx4 v[208:211], v83, s[20:21] nt
  v_min_u32 v84, 23, v80
  v_lshlrev_b32 v84, 10, v84
  v_lshl_add_u32 v84, v81, 4, v84
  s_add_u32 s40, s40, 0x8000
  v_add_u32 v84, s40, v84
  global_load_dwordx4 v[212:215], v84, s[20:21] nt
L_now:
  s_cmp_lg_u32 s39, 0
  s_cbranch_scc1 L_nonear
  v_mov_b32 v44, 21584
  s_mov_b32 s62, 1048576
L_pnear:
  ds_read_b32 v45, v44
  s_waitcnt lgkmcnt(0)
  v_readfirstlane_b32 s41, v45
  s_sub_u32 s62, s62, 1
  s_cmp_eq_u32 s62, 0
  s_cbranch_scc1 L_pnear_done
  s_cmp_ge_u32 s41, 1
  s_cbranch_scc1 L_pnear_done
  s_sleep 32
  s_branch L_pnear
L_pnear_done:
L_nonear:
  s_lshl_b32 s66, s39, 8
  s_lshl_b32 s41, s37, 3
  s_add_u32 s66, s66, s41
  s_lshr_b32 s40, s63, 1
  s_add_u32 s40, s40, s66
  s_lshl_b32 s40, s40, 12
  s_and_b32 s41, s63, 1
  s_lshl_b32 s41, s41, 10
  s_add_u32 s40, s40, s41
  s_add_u32 s40, s40, 0x20000
  v_lshlrev_b32 v32, 4, v3
  v_add_u32 v32, s40, v32
  v_add_u32 v33, 8192, v32
  v_add_u32 v34, 16384, v32
  v_add_u32 v35, 24576, v32
  v_lshrrev_b32 v36, 1, v4
  v_lshlrev_b32 v36, 12, v36
  v_and_b32 v37, 1, v4
  v_lshl_add_u32 v36, v37, 4, v36
  s_lshl_b32 s40, s66, 12
  s_add_u32 s40, s40, 0x20800
  v_add_u32 v36, s40, v36
  s_mov_b32 s42, 0x5bd1e995
  s_mov_b32 s62, 1048576
L_pollP:
  global_load_dwordx4 v[96:99], v32, s[26:27] sc0 sc1
  global_load_dwordx4 v[100:103], v33, s[26:27] sc0 sc1
  global_load_dwordx4 v[104:107], v34, s[26:27] sc0 sc1
  global_load_dwordx4 v[108:111], v35, s[26:27] sc0 sc1
  global_load_dwordx4 v[112:115], v36, s[26:27] sc0 sc1
  s_waitcnt vmcnt(0)
  v_xor_b32 v38, s42, v97
  v_xor_b32 v39, s42, v99
  v_or_b32 v38, v38, v39
  v_xor_b32 v39, s42, v101
  v_or_b32 v38, v38, v39
  v_xor_b32 v39, s42, v103
  v_or_b32 v38, v38, v39
  v_xor_b32 v39, s42, v105
  v_or_b32 v38, v38, v39
  v_xor_b32 v39, s42, v107
  v_or_b32 v38, v38, v39
  v_xor_b32 v39, s42, v109
  v_or_b32 v38, v38, v39
  v_xor_b32 v39, s42, v111
  v_or_b32 v38, v38, v39
  v_xor_b32 v39, s42, v113
  v_or_b32 v38, v38, v39
  v_xor_b32 v39, s42, v115
  v_or_b32 v38, v38, v39
  v_cmp_ne_u32 vcc, 0, v38
  s_sub_u32 s62, s62, 1
  s_cmp_eq_u32 s62, 0
  s_cbranch_scc1 L_pollP_done
  s_cbranch_vccz L_pollP_done
  s_sleep 1
  s_branch L_pollP
L_pollP_done:
  v_max_f32 v38, v112, v132
  s_nop 1
  v_max_f32_dpp v38, v38, v38 row_ror:2 row_mask:0xf bank_mask:0xf
  s_nop 1
  v_max_f32_dpp v38, v38, v38 row_ror:4 row_mask:0xf bank_mask:0xf
  s_nop 1
  v_max_f32_dpp v38, v38, v38 row_ror:8 row_mask:0xf bank_mask:0xf
  v_sub_f32 v39, v112, v38
  v_sub_f32 v41, v132, v38
  v_mul_f32 v39, s50, v39
  v_mul_f32 v41, s50, v41
  v_exp_f32 v39, v39
  v_exp_f32 v41, v41
  s_nop 0
  v_mul_f32 v40, v39, v114
  s_nop 1
  v_add_f32_dpp v40, v40, v40 row_ror:2 row_mask:0xf bank_mask:0xf
  s_nop 1
  v_add_f32_dpp v40, v40, v40 row_ror:4 row_mask:0xf bank_mask:0xf
  s_nop 1
  v_add_f32_dpp v40, v40, v40 row_ror:8 row_mask:0xf bank_mask:0xf
  v_fma_f32 v133, v133, v41, v40
  v_mov_b32 v132, v38
  s_and_b32 s40, s63, 1
  s_nop 0
  v_readlane_b32 s41, v41, s40
  s_nop 1
  v_mul_f32 v134, s41, v134
  v_mul_f32 v135, s41, v135
  s_add_u32 s40, s63, 0
  s_nop 0
  v_readlane_b32 s41, v39, s40
  s_nop 1
  v_fmac_f32 v134, s41, v96
  v_fmac_f32 v135, s41, v98
  s_add_u32 s40, s63, 4
  s_nop 0
  v_readlane_b32 s41, v39, s40
  s_nop 1
  v_fmac_f32 v134, s41, v100
  v_fmac_f32 v135, s41, v102
  s_add_u32 s40, s63, 8
  s_nop 0
  v_readlane_b32 s41, v39, s40
  s_nop 1
  v_fmac_f32 v134, s41, v104
  v_fmac_f32 v135, s41, v106
  s_add_u32 s40, s63, 12
  s_nop 0
  v_readlane_b32 s41, v39, s40
  s_nop 1
  v_fmac_f32 v134, s41, v108
  v_fmac_f32 v135, s41, v110
  s_cmp_eq_u32 s39, 0
  s_mov_b32 s39, 1
  s_cbranch_scc1 L_round
  v_rcp_f32 v41, v133
  s_and_b32 s40, s63, 1
  s_nop 0
  v_fma_f32 v42, -v133, v41, 1.0
  v_fma_f32 v41, v42, v41, v41
  s_nop 0
  v_readlane_b32 s41, v41, s40
  s_nop 1
  v_mul_f32 v44, s41, v134
  v_mul_f32 v45, s41, v135
  s_lshl_b32 s40, s63, 2
  v_lshlrev_b32 v32, 5, v3
  v_add_u32 v32, s40, v32
  ds_write_b32 v32, v44 offset:17472
  ds_write_b32 v32, v45 offset:17488
  s_waitcnt lgkmcnt(0)
  s_barrier
  v_lshrrev_b32 v32, 3, v1
  v_lshlrev_b32 v33, 4, v32
  ds_read_b128 v[96:99], v33 offset:17472
  ds_read_b128 v[100:103], v33 offset:17984
  ds_read_b128 v[104:107], v33 offset:18496
  ds_read_b128 v[108:111], v33 offset:19008
  v_lshlrev_b32 v34, 3, v32
  ds_read_b64 v[36:37], v34 offset:12800
  ds_read_b64 v[38:39], v34 offset:13056
  s_waitcnt vmcnt(0) lgkmcnt(0)
  v_add_f32 v96, v96, v98
  v_add_f32 v97, v97, v99
  v_cvt_pk_bf16_f32 v96, v96, v96
  v_and_b32 v96, s64, v96
  v_cvt_pk_bf16_f32 v97, v97, v97
  v_and_b32 v97, s64, v97
  v_add_f32 v100, v100, v102
  v_add_f32 v101, v101, v103
  v_cvt_pk_bf16_f32 v100, v100, v100
  v_and_b32 v100, s64, v100
  v_cvt_pk_bf16_f32 v101, v101, v101
  v_and_b32 v101, s64, v101
  v_add_f32 v104, v104, v106
  v_add_f32 v105, v105, v107
  v_cvt_pk_bf16_f32 v104, v104, v104
  v_and_b32 v104, s64, v104
  v_cvt_pk_bf16_f32 v105, v105, v105
  v_and_b32 v105, s64, v105
  v_add_f32 v108, v108, v110
  v_add_f32 v109, v109, v111
  v_cvt_pk_bf16_f32 v108, v108, v108
  v_and_b32 v108, s64, v108
  v_cvt_pk_bf16_f32 v109, v109, v109
  v_and_b32 v109, s64, v109
  v_lshlrev_b32 v80, 16, v192
  v_and_b32 v81, s64, v192
  v_lshlrev_b32 v82, 16, v193
  v_and_b32 v83, s64, v193
  v_lshlrev_b32 v84, 16, v194
  v_and_b32 v85, s64, v194
  v_lshlrev_b32 v86, 16, v195
  v_and_b32 v87, s64, v195
  v_mul_f32 v116, v80, v96
  v_mul_f32 v117, v81, v96
  v_mul_f32 v118, v82, v96
  v_mul_f32 v119, v83, v96
  v_mul_f32 v120, v84, v96
  v_mul_f32 v121, v85, v96
  v_mul_f32 v122, v86, v96
  v_mul_f32 v123, v87, v96
  v_mul_f32 v124, v80, v97
  v_mul_f32 v125, v81, v97
  v_mul_f32 v126, v82, v97
  v_mul_f32 v127, v83, v97
  v_mul_f32 v128, v84, v97
  v_mul_f32 v129, v85, v97
  v_mul_f32 v130, v86, v97
  v_mul_f32 v131, v87, v97
  v_lshlrev_b32 v80, 16, v196
  v_and_b32 v81, s64, v196
  v_lshlrev_b32 v82, 16, v197
  v_and_b32 v83, s64, v197
  v_lshlrev_b32 v84, 16, v198
  v_and_b32 v85, s64, v198
  v_lshlrev_b32 v86, 16, v199
  v_and_b32 v87, s64, v199
  v_fmac_f32 v116, v80, v100
  v_fmac_f32 v117, v81, v100
  v_fmac_f32 v118, v82, v100
  v_fmac_f32 v119, v83, v100
  v_fmac_f32 v120, v84, v100
  v_fmac_f32 v121, v85, v100
  v_fmac_f32 v122, v86, v100
  v_fmac_f32 v123, v87, v100
  v_fmac_f32 v124, v80, v101
  v_fmac_f32 v125, v81, v101
  v_fmac_f32 v126, v82, v101
  v_fmac_f32 v127, v83, v101
  v_fmac_f32 v128, v84, v101
  v_fmac_f32 v129, v85, v101
  v_fmac_f32 v130, v86, v101
  v_fmac_f32 v131, v87, v101
  v_lshlrev_b32 v80, 16, v200
  v_and_b32 v81, s64, v200
  v_lshlrev_b32 v82, 16, v201
  v_and_b32 v83, s64, v201
  v_lshlrev_b32 v84, 16, v202
  v_and_b32 v85, s64, v202
  v_lshlrev_b32 v86, 16, v203
  v_and_b32 v87, s64, v203
  v_fmac_f32 v116, v80, v104
  v_fmac_f32 v117, v81, v104
  v_fmac_f32 v118, v82, v104
  v_fmac_f32 v119, v83, v104
  v_fmac_f32 v120, v84, v104
  v_fmac_f32 v121, v85, v104
  v_fmac_f32 v122, v86, v104
  v_fmac_f32 v123, v87, v104
  v_fmac_f32 v124, v80, v105
  v_fmac_f32 v125, v81, v105
  v_fmac_f32 v126, v82, v105
  v_fmac_f32 v127, v83, v105
  v_fmac_f32 v128, v84, v105
  v_fmac_f32 v129, v85, v105
  v_fmac_f32 v130, v86, v105
  v_fmac_f32 v131, v87, v105
  v_lshlrev_b32 v80, 16, v204
  v_and_b32 v81, s64, v204
  v_lshlrev_b32 v82, 16, v205
  v_and_b32 v83, s64, v205
  v_lshlrev_b32 v84, 16, v206
  v_and_b32 v85, s64, v206
  v_lshlrev_b32 v86, 16, v207
  v_and_b32 v87, s64, v207
  v_fmac_f32 v116, v80, v108
  v_fmac_f32 v117, v81, v108
  v_fmac_f32 v118, v82, v108
  v_fmac_f32 v119, v83, v108
  v_fmac_f32 v120, v84, v108
  v_fmac_f32 v121, v85, v108
  v_fmac_f32 v122, v86, v108
  v_fmac_f32 v123, v87, v108
  v_fmac_f32 v124, v80, v109
  v_fmac_f32 v125, v81, v109
  v_fmac_f32 v126, v82, v109
  v_fmac_f32 v127, v83, v109
  v_fmac_f32 v128, v84, v109
  v_fmac_f32 v129, v85, v109
  v_fmac_f32 v130, v86, v109
  v_fmac_f32 v131, v87, v109
  v_lshlrev_b32 v80, 16, v208
  v_and_b32 v81, s64, v208
  v_lshlrev_b32 v82, 16, v209
  v_and_b32 v83, s64, v209
  v_lshlrev_b32 v84, 16, v210
  v_and_b32 v85, s64, v210
  v_lshlrev_b32 v86, 16, v211
  v_and_b32 v87, s64, v211
  v_fmac_f32 v116, v80, v36
  v_fmac_f32 v117, v81, v36
  v_fmac_f32 v118, v82, v36
  v_fmac_f32 v119, v83, v36
  v_fmac_f32 v120, v84, v36
  v_fmac_f32 v121, v85, v36
  v_fmac_f32 v122, v86, v36
  v_fmac_f32 v123, v87, v36
  v_fmac_f32 v124, v80, v37
  v_fmac_f32 v125, v81, v37
  v_fmac_f32 v126, v82, v37
  v_fmac_f32 v127, v83, v37
  v_fmac_f32 v128, v84, v37
  v_fmac_f32 v129, v85, v37
  v_fmac_f32 v130, v86, v37
  v_fmac_f32 v131, v87, v37
  v_lshlrev_b32 v80, 16, v212
  v_and_b32 v81, s64, v212
  v_lshlrev_b32 v82, 16, v213
  v_and_b32 v83, s64, v213
  v_lshlrev_b32 v84, 16, v214
  v_and_b32 v85, s64, v214
  v_lshlrev_b32 v86, 16, v215
  v_and_b32 v87, s64, v215
  v_fmac_f32 v116, v80, v38
  v_fmac_f32 v117, v81, v38
  v_fmac_f32 v118, v82, v38
  v_fmac_f32 v119, v83, v38
  v_fmac_f32 v120, v84, v38
  v_fmac_f32 v121, v85, v38
  v_fmac_f32 v122, v86, v38
  v_fmac_f32 v123, v87, v38
  v_fmac_f32 v124, v80, v39
  v_fmac_f32 v125, v81, v39
  v_fmac_f32 v126, v82, v39
  v_fmac_f32 v127, v83, v39
  v_fmac_f32 v128, v84, v39
  v_fmac_f32 v129, v85, v39
  v_fmac_f32 v130, v86, v39
  v_fmac_f32 v131, v87, v39
  s_nop 1
  v_permlane32_swap_b32 v116, v124
  v_permlane32_swap_b32 v117, v125
  v_permlane32_swap_b32 v118, v126
  v_permlane32_swap_b32 v119, v127
  v_permlane32_swap_b32 v120, v128
  v_permlane32_swap_b32 v121, v129
  v_permlane32_swap_b32 v122, v130
  v_permlane32_swap_b32 v123, v131
  s_nop 1
  v_add_f32 v116, v116, v124
  v_add_f32 v117, v117, v125
  v_add_f32 v118, v118, v126
  v_add_f32 v119, v119, v127
  v_add_f32 v120, v120, v128
  v_add_f32 v121, v121, v129
  v_add_f32 v122, v122, v130
  v_add_f32 v123, v123, v131
  s_nop 1
  v_permlane16_swap_b32 v116, v120
  v_permlane16_swap_b32 v117, v121
  v_permlane16_swap_b32 v118, v122
  v_permlane16_swap_b32 v119, v123
  s_nop 1
  v_add_f32 v116, v116, v120
  v_add_f32 v117, v117, v121
  v_add_f32 v118, v118, v122
  v_add_f32 v119, v119, v123
  s_nop 1
  v_add_f32_dpp v116, v116, v116 row_ror:8 row_mask:0xf bank_mask:0xf
  v_add_f32_dpp v117, v117, v117 row_ror:8 row_mask:0xf bank_mask:0xf
  v_add_f32_dpp v118, v118, v118 row_ror:8 row_mask:0xf bank_mask:0xf
  v_add_f32_dpp v119, v119, v119 row_ror:8 row_mask:0xf bank_mask:0xf
  v_lshrrev_b32 v32, 1, v5
  v_lshlrev_b32 v32, 8, v32
  v_and_b32 v33, 1, v5
  v_lshl_add_u32 v32, v33, 4, v32
  v_and_b32 v33, 7, v4
  v_lshl_add_u32 v32, v33, 5, v32
  s_lshl_b32 s40, s63, 9
  v_add_u32 v32, s40, v32
  v_cmp_gt_u32 vcc, 8, v4
  s_and_saveexec_b64 s[56:57], vcc
  ds_write_b128 v32, v[116:119] offset:19520
  s_mov_b64 exec, s[56:57]
  s_waitcnt lgkmcnt(0)
  s_barrier
  s_cmp_lg_u32 s63, 0
  s_cbranch_scc1 L_end_h
  v_lshrrev_b32 v32, 1, v3
  v_and_b32 v33, 1, v3
  v_lshlrev_b32 v34, 8, v33
  v_lshl_add_u32 v34, v32, 3, v34
  ds_read_b64 v[36:37], v34 offset:19520
  ds_read_b64 v[38:39], v34 offset:20032
  ds_read_b64 v[40:41], v34 offset:20544
  ds_read_b64 v[42:43], v34 offset:21056
  s_waitcnt lgkmcnt(0)
  v_add_f32 v36, v36, v38
  v_add_f32 v37, v37, v39
  v_add_f32 v40, v40, v42
  v_add_f32 v41, v41, v43
  v_add_f32 v96, v36, v40
  v_add_f32 v98, v37, v41
  v_mov_b32 v97, 0x5bd1e995
  v_mov_b32 v99, 0x5bd1e995
  s_lshl_b32 s40, s38, 15
  s_lshl_b32 s41, s37, 5
  s_add_u32 s40, s40, s41
  s_add_u32 s40, s40, 0x300000
  v_lshlrev_b32 v34, 10, v32
  v_lshl_add_u32 v34, v33, 4, v34
  v_add_u32 v34, s40, v34
  global_store_dwordx4 v34, v[96:99], s[26:27] sc0 sc1
  s_lshl_b32 s40, s38, 5
  s_add_u32 s40, s40, s37
  s_lshl_b32 s40, s40, 10
  s_add_u32 s40, s40, 0x300000
  v_lshlrev_b32 v35, 4, v3
  v_add_u32 v35, s40, v35
  s_lshl_b32 s40, s38, 7
  s_lshl_b32 s41, s37, 2
  s_add_u32 s40, s40, s41
  v_lshlrev_b32 v36, 10, v33
  v_add_u32 v36, s40, v36
  global_load_dword v37, v36, s[4:5]
  s_mov_b32 s42, 0x5bd1e995
  s_mov_b32 s62, 1048576
L_pollY:
  global_load_dwordx4 v[100:103], v35, s[26:27] sc0 sc1
  s_waitcnt vmcnt(0)
  v_xor_b32 v38, s42, v101
  v_xor_b32 v39, s42, v103
  v_or_b32 v38, v38, v39
  v_cmp_ne_u32 vcc, 0, v38
  s_sub_u32 s62, s62, 1
  s_cmp_eq_u32 s62, 0
  s_cbranch_scc1 L_pollY_done
  s_cbranch_vccz L_pollY_done
  s_sleep 1
  s_branch L_pollY
L_pollY_done:
  s_nop 1
  v_add_f32_dpp v100, v100, v100 row_ror:2 row_mask:0xf bank_mask:0xf
  v_add_f32_dpp v102, v102, v102 row_ror:2 row_mask:0xf bank_mask:0xf
  s_nop 1
  v_add_f32_dpp v100, v100, v100 row_ror:4 row_mask:0xf bank_mask:0xf
  v_add_f32_dpp v102, v102, v102 row_ror:4 row_mask:0xf bank_mask:0xf
  s_nop 1
  v_add_f32_dpp v100, v100, v100 row_ror:8 row_mask:0xf bank_mask:0xf
  v_add_f32_dpp v102, v102, v102 row_ror:8 row_mask:0xf bank_mask:0xf
  v_mov_b32 v38, v100
  v_mov_b32 v39, v102
  s_nop 1
  v_permlane16_swap_b32 v100, v38
  v_permlane16_swap_b32 v102, v39
  s_nop 1
  v_add_f32 v100, v100, v38
  v_add_f32 v102, v102, v39
  v_mov_b32 v38, v100
  v_mov_b32 v39, v102
  s_nop 1
  v_permlane32_swap_b32 v100, v38
  v_permlane32_swap_b32 v102, v39
  s_nop 1
  v_add_f32 v100, v100, v38
  v_add_f32 v102, v102, v39
  v_lshlrev_b32 v38, 16, v37
  v_and_b32 v39, s64, v37
  v_add_f32 v100, v100, v38
  v_add_f32 v102, v102, v39
  v_cvt_pk_bf16_f32 v40, v100, v102
  s_mov_b64 exec, 3
  global_store_dword v36, v40, s[22:23]
  s_mov_b64 exec, -1
L_end_h:
L_done:
s_endpgm
.section .rodata,"a"
.p2align 6
.amdhsa_kernel parallel_sum__mha_block_cached__glu_gated_swiglu__decode_kernel
  .amdhsa_next_free_vgpr 216
  .amdhsa_next_free_sgpr 80
  .amdhsa_accum_offset 216
  .amdhsa_group_segment_fixed_size 0
  .amdhsa_kernarg_size 96
  .amdhsa_user_sgpr_count 2
  .amdhsa_user_sgpr_kernarg_segment_ptr 1
  .amdhsa_system_sgpr_workgroup_id_x 1
.end_amdhsa_kernel
```
